```python
import torch

def _softmax(x, axis=-1):
    return torch.softmax(x, dim=axis)
def _gelu(x):
    return torch.nn.functional.gelu(x, approximate="tanh")
def _silu(x):
    return torch.nn.functional.silu(x)
def _sigmoid(x):
    return torch.sigmoid(x)
def _layernorm(x, axis=-1, eps=1e-5):
    m = x.mean(dim=axis, keepdim=True)
    v = x.var(dim=axis, keepdim=True, unbiased=False)
    return (x - m) / torch.sqrt(v + eps)
def _scatter_add(tgt, idx, src, axis=0):
    return tgt.clone().index_add_(axis, idx, src)
def _segment_sum(src, seg, n):
    out = torch.zeros((n,) + src.shape[1:], dtype=src.dtype)
    return out.index_add_(0, seg, src)
def _pad(x, pw):
    flat = tuple(v for pair in reversed(pw) for v in pair)
    return torch.nn.functional.pad(x, flat)

kernel_name = 'parallel_sum__mha_block_cached__swiglu_ffn__decode'

def setup_inputs():

    _w = (lambda a: (lambda t: t.to(torch.bfloat16) if t.is_floating_point() else t)(torch.as_tensor(a)))
    def _A_setup():
        B, Sq, D = 4, 1, 512
        H, Sk, Dh = 32, 8192, 128
        return {
            "x": _w((lambda *s: torch.randn(*s, dtype=torch.bfloat16) * 0.05)(B, Sq, D)),
            "k_cache": _w((lambda *s: torch.randn(*s, dtype=torch.bfloat16) * 3.2)(B, H, Sk, Dh)),
            "v_cache": _w((lambda *s: torch.randn(*s, dtype=torch.bfloat16) * 1.6)(B, H, Sk, Dh)),
            "wq": _w((lambda *s: torch.randn(*s, dtype=torch.bfloat16) * 3.2)(D, H * Dh) * (D ** -0.5)),
            "wo": _w((lambda *s: torch.randn(*s, dtype=torch.bfloat16) * 1.6)(H * Dh, D) * ((H * Dh) ** -0.5)),
        }
    _A_in = _A_setup()

    def _B_setup():
        B, S, D, F = 4, 1, 512, 1792
        return {
            "x": _w((lambda *s: torch.randn(*s, dtype=torch.bfloat16) * 0.05)(B, S, D)),
            "w_gate": _w((lambda *s: torch.randn(*s, dtype=torch.bfloat16) * 0.05)(D, F)),
            "w_up": _w((lambda *s: torch.randn(*s, dtype=torch.bfloat16) * 0.05)(D, F)),
            "w_down": _w((lambda *s: torch.randn(*s, dtype=torch.bfloat16) * 0.05)(F, D)),
        }
    _B_in = _B_setup()

    return {
        "A_x": _A_in["x"],
        "A_k_cache": _A_in["k_cache"],
        "A_v_cache": _A_in["v_cache"],
        "A_wq": _A_in["wq"],
        "A_wo": _A_in["wo"],
        "B_x": _B_in["x"],
        "B_w_gate": _B_in["w_gate"],
        "B_w_up": _B_in["w_up"],
        "B_w_down": _B_in["w_down"],
    }

def reference(A_x, A_k_cache, A_v_cache, A_wq, A_wo, B_x, B_w_gate, B_w_up, B_w_down):
    def _A_ref(x, k_cache, v_cache, wq, wo):
        B, Sq, D = x.shape
        H, Dh = 32, 128
        q = (lambda x, *d: x.permute(*d))((x @ wq).reshape(B, Sq, H, Dh), 0, 2, 1, 3)
        scores = torch.einsum("bhqd,bhkd->bhqk", q, k_cache) * (Dh ** -0.5)
        p = _softmax(scores, axis=-1)
        o = torch.einsum("bhqk,bhkd->bhqd", p, v_cache)
        return (lambda x, *d: x.permute(*d))(o, 0, 2, 1, 3).reshape(B, Sq, H * Dh) @ wo

    def _B_ref(x, w_gate, w_up, w_down):
        g = _silu(x @ w_gate)
        u = x @ w_up
        return (g * u) @ w_down

    x = A_x
    xn = _layernorm(x, axis=-1)
    return x + _A_ref(xn, A_k_cache, A_v_cache, A_wq, A_wo) + _B_ref(xn, B_w_gate, B_w_up, B_w_down)
```

```asm
; @launch kernel=parallel_sum__mha_block_cached__swiglu_ffn__decode_kernel grid=(256,1,1) block=(512,1,1) lds=131072
; @launch kernel=final_reduce_kernel grid=(32,1,1) block=(256,1,1) lds=8192
.amdgcn_target "amdgcn-amd-amdhsa--gfx950"
.text
.globl parallel_sum__mha_block_cached__swiglu_ffn__decode_kernel
.p2align 8
.type parallel_sum__mha_block_cached__swiglu_ffn__decode_kernel,@function
parallel_sum__mha_block_cached__swiglu_ffn__decode_kernel:
    s_cmp_ge_u32 s2, 256
    s_cbranch_scc1 L_main_end
    s_load_dwordx16 s[4:19], s[0:1], 0
    s_load_dwordx8 s[20:27], s[0:1], 64
    v_and_b32 v1, 63, v0
    v_lshrrev_b32 v5, 6, v0
    v_and_b32 v2, 15, v0
    v_bfe_u32 v3, v0, 4, 2
    v_readfirstlane_b32 s32, v5
    s_and_b32 s28, s2, 7
    s_lshr_b32 s33, s2, 3
    s_and_b32 s33, s33, 3
    s_lshl_b32 s33, s33, 3
    s_or_b32 s28, s28, s33
    s_lshr_b32 s33, s2, 5
    s_lshr_b32 s29, s33, 1
    s_and_b32 s30, s33, 1
    s_lshl_b32 s31, s28, 1
    s_or_b32 s31, s31, s30
    s_add_u32 s54, s32, s33
    s_and_b32 s54, s54, 7
    s_mov_b32 s44, 0x3db504f3
    s_mov_b32 s45, 0x3fb8aa3b
    s_mov_b32 s46, 0xffff0000
    v_lshlrev_b32 v6, 4, v1
    s_waitcnt lgkmcnt(0)
    s_lshl_b32 s33, s29, 10
    s_add_u32 s34, s4, s33
    s_addc_u32 s35, s5, 0
    global_load_dwordx4 v[32:35], v6, s[34:35]
    s_lshl_b32 s33, s29, 5
    s_add_u32 s33, s33, s28
    s_lshl_b32 s33, s33, 1
    s_add_u32 s33, s33, s30
    s_lshl_b32 s33, s33, 20
    s_add_u32 s36, s6, s33
    s_addc_u32 s37, s7, 0
    s_add_u32 s38, s8, s33
    s_addc_u32 s39, s9, 0
    s_and_b32 s33, s32, 1
    s_lshl_b32 s33, s33, 11
    s_lshr_b32 s34, s32, 1
    s_lshl_b32 s34, s34, 14
    s_add_u32 s33, s33, s34
    v_lshlrev_b32 v4, 12, v3
    v_lshl_add_u32 v4, v2, 4, v4
    v_add_u32 v4, s33, v4
    global_load_dwordx4 v[64:67], v4, s[36:37] offset:0 nt
    global_load_dwordx4 v[68:71], v4, s[36:37] offset:256 nt
    global_load_dwordx4 v[72:75], v4, s[36:37] offset:512 nt
    global_load_dwordx4 v[76:79], v4, s[36:37] offset:768 nt
    global_load_dwordx4 v[80:83], v4, s[36:37] offset:1024 nt
    global_load_dwordx4 v[84:87], v4, s[36:37] offset:1280 nt
    global_load_dwordx4 v[88:91], v4, s[36:37] offset:1536 nt
    global_load_dwordx4 v[92:95], v4, s[36:37] offset:1792 nt
    s_lshl_b32 s33, s28, 8
    s_add_u32 s40, s10, s33
    s_addc_u32 s41, s11, 0
    s_lshl_b32 s33, s54, 19
    v_lshlrev_b32 v7, 17, v3
    v_lshl_add_u32 v7, v2, 4, v7
    v_add_u32 v7, s33, v7
    global_load_dwordx4 v[192:195], v7, s[40:41]
    v_add_u32 v7, 0x2000, v7
    global_load_dwordx4 v[196:199], v7, s[40:41]
    v_add_u32 v7, 0x2000, v7
    global_load_dwordx4 v[200:203], v7, s[40:41]
    v_add_u32 v7, 0x2000, v7
    global_load_dwordx4 v[204:207], v7, s[40:41]
    v_add_u32 v7, 0x2000, v7
    global_load_dwordx4 v[208:211], v7, s[40:41]
    v_add_u32 v7, 0x2000, v7
    global_load_dwordx4 v[212:215], v7, s[40:41]
    v_add_u32 v7, 0x2000, v7
    global_load_dwordx4 v[216:219], v7, s[40:41]
    v_add_u32 v7, 0x2000, v7
    global_load_dwordx4 v[220:223], v7, s[40:41]
    v_add_u32 v7, 0x2000, v7
    global_load_dwordx4 v[224:227], v7, s[40:41]
    v_add_u32 v7, 0x2000, v7
    global_load_dwordx4 v[228:231], v7, s[40:41]
    v_add_u32 v7, 0x2000, v7
    global_load_dwordx4 v[232:235], v7, s[40:41]
    v_add_u32 v7, 0x2000, v7
    global_load_dwordx4 v[236:239], v7, s[40:41]
    v_add_u32 v7, 0x2000, v7
    global_load_dwordx4 v[240:243], v7, s[40:41]
    v_add_u32 v7, 0x2000, v7
    global_load_dwordx4 v[244:247], v7, s[40:41]
    v_add_u32 v7, 0x2000, v7
    global_load_dwordx4 v[248:251], v7, s[40:41]
    v_add_u32 v7, 0x2000, v7
    global_load_dwordx4 v[252:255], v7, s[40:41]
    global_load_dwordx4 v[96:99], v4, s[38:39] offset:0 nt
    global_load_dwordx4 v[100:103], v4, s[38:39] offset:256 nt
    global_load_dwordx4 v[104:107], v4, s[38:39] offset:512 nt
    global_load_dwordx4 v[108:111], v4, s[38:39] offset:768 nt
    global_load_dwordx4 v[112:115], v4, s[38:39] offset:1024 nt
    global_load_dwordx4 v[116:119], v4, s[38:39] offset:1280 nt
    global_load_dwordx4 v[120:123], v4, s[38:39] offset:1536 nt
    global_load_dwordx4 v[124:127], v4, s[38:39] offset:1792 nt
    v_add_u32 v4, 65536, v4
    s_waitcnt vmcnt(32)
    v_lshlrev_b32 v48, 16, v32
    v_and_b32 v49, s46, v32
    v_lshlrev_b32 v50, 16, v33
    v_and_b32 v51, s46, v33
    v_lshlrev_b32 v52, 16, v34
    v_and_b32 v53, s46, v34
    v_lshlrev_b32 v54, 16, v35
    v_and_b32 v55, s46, v35
    v_add_f32 v36, v48, v49
    v_add_f32 v37, v50, v51
    v_add_f32 v38, v52, v53
    v_add_f32 v39, v54, v55
    v_add_f32 v36, v36, v37
    v_add_f32 v38, v38, v39
    v_add_f32 v36, v36, v38
    s_nop 1
    v_add_f32_dpp v36, v36, v36 row_ror:8 row_mask:0xf bank_mask:0xf
    s_nop 1
    v_add_f32_dpp v36, v36, v36 row_ror:4 row_mask:0xf bank_mask:0xf
    s_nop 1
    v_add_f32_dpp v36, v36, v36 row_ror:2 row_mask:0xf bank_mask:0xf
    s_nop 1
    v_add_f32_dpp v36, v36, v36 row_ror:1 row_mask:0xf bank_mask:0xf
    s_nop 0
    v_readlane_b32 s48, v36, 0
    v_readlane_b32 s49, v36, 16
    v_readlane_b32 s50, v36, 32
    v_readlane_b32 s51, v36, 48
    v_mov_b32 v36, s48
    v_add_f32 v36, s49, v36
    v_mov_b32 v47, s50
    v_add_f32 v47, s51, v47
    v_add_f32 v36, v36, v47
    v_mul_f32 v36, 0x3b000000, v36
    v_cvt_pk_bf16_f32 v37, v36, v36
    v_lshlrev_b32 v37, 16, v37
    v_sub_f32 v38, v48, v36
    v_mul_f32 v39, v38, v38
    v_sub_f32 v38, v49, v36
    v_fmac_f32 v39, v38, v38
    v_sub_f32 v38, v50, v36
    v_fmac_f32 v39, v38, v38
    v_sub_f32 v38, v51, v36
    v_fmac_f32 v39, v38, v38
    v_sub_f32 v38, v52, v36
    v_fmac_f32 v39, v38, v38
    v_sub_f32 v38, v53, v36
    v_fmac_f32 v39, v38, v38
    v_sub_f32 v38, v54, v36
    v_fmac_f32 v39, v38, v38
    v_sub_f32 v38, v55, v36
    v_fmac_f32 v39, v38, v38
    s_nop 1
    v_add_f32_dpp v39, v39, v39 row_ror:8 row_mask:0xf bank_mask:0xf
    s_nop 1
    v_add_f32_dpp v39, v39, v39 row_ror:4 row_mask:0xf bank_mask:0xf
    s_nop 1
    v_add_f32_dpp v39, v39, v39 row_ror:2 row_mask:0xf bank_mask:0xf
    s_nop 1
    v_add_f32_dpp v39, v39, v39 row_ror:1 row_mask:0xf bank_mask:0xf
    s_nop 0
    v_readlane_b32 s48, v39, 0
    v_readlane_b32 s49, v39, 16
    v_readlane_b32 s50, v39, 32
    v_readlane_b32 s51, v39, 48
    v_mov_b32 v39, s48
    v_add_f32 v39, s49, v39
    v_mov_b32 v47, s50
    v_add_f32 v47, s51, v47
    v_add_f32 v39, v39, v47
    v_mul_f32 v39, 0x3b000000, v39
    v_cvt_pk_bf16_f32 v39, v39, v39
    v_lshlrev_b32 v39, 16, v39
    v_add_f32 v39, 0x3727c5ac, v39
    v_cvt_pk_bf16_f32 v39, v39, v39
    v_lshlrev_b32 v39, 16, v39
    v_sqrt_f32 v40, v39
    s_nop 0
    v_rcp_f32 v41, v40
    v_fma_f32 v42, -v40, v40, v39
    v_mul_f32 v41, 0.5, v41
    v_fmac_f32 v40, v42, v41
    v_cvt_pk_bf16_f32 v40, v40, v40
    v_lshlrev_b32 v40, 16, v40
    v_rcp_f32 v41, v40
    v_sub_f32 v42, v48, v37
    v_cvt_pk_bf16_f32 v42, v42, v42
    v_lshlrev_b32 v42, 16, v42
    v_mul_f32 v43, v42, v41
    v_fma_f32 v44, -v43, v40, v42
    v_fmac_f32 v43, v44, v41
    v_cvt_pk_bf16_f32 v56, v43, v43
    v_lshlrev_b32 v56, 16, v56
    v_sub_f32 v42, v49, v37
    v_cvt_pk_bf16_f32 v42, v42, v42
    v_lshlrev_b32 v42, 16, v42
    v_mul_f32 v43, v42, v41
    v_fma_f32 v44, -v43, v40, v42
    v_fmac_f32 v43, v44, v41
    v_cvt_pk_bf16_f32 v57, v43, v43
    v_lshlrev_b32 v57, 16, v57
    v_sub_f32 v42, v50, v37
    v_cvt_pk_bf16_f32 v42, v42, v42
    v_lshlrev_b32 v42, 16, v42
    v_mul_f32 v43, v42, v41
    v_fma_f32 v44, -v43, v40, v42
    v_fmac_f32 v43, v44, v41
    v_cvt_pk_bf16_f32 v58, v43, v43
    v_lshlrev_b32 v58, 16, v58
    v_sub_f32 v42, v51, v37
    v_cvt_pk_bf16_f32 v42, v42, v42
    v_lshlrev_b32 v42, 16, v42
    v_mul_f32 v43, v42, v41
    v_fma_f32 v44, -v43, v40, v42
    v_fmac_f32 v43, v44, v41
    v_cvt_pk_bf16_f32 v59, v43, v43
    v_lshlrev_b32 v59, 16, v59
    v_sub_f32 v42, v52, v37
    v_cvt_pk_bf16_f32 v42, v42, v42
    v_lshlrev_b32 v42, 16, v42
    v_mul_f32 v43, v42, v41
    v_fma_f32 v44, -v43, v40, v42
    v_fmac_f32 v43, v44, v41
    v_cvt_pk_bf16_f32 v60, v43, v43
    v_lshlrev_b32 v60, 16, v60
    v_sub_f32 v42, v53, v37
    v_cvt_pk_bf16_f32 v42, v42, v42
    v_lshlrev_b32 v42, 16, v42
    v_mul_f32 v43, v42, v41
    v_fma_f32 v44, -v43, v40, v42
    v_fmac_f32 v43, v44, v41
    v_cvt_pk_bf16_f32 v61, v43, v43
    v_lshlrev_b32 v61, 16, v61
    v_sub_f32 v42, v54, v37
    v_cvt_pk_bf16_f32 v42, v42, v42
    v_lshlrev_b32 v42, 16, v42
    v_mul_f32 v43, v42, v41
    v_fma_f32 v44, -v43, v40, v42
    v_fmac_f32 v43, v44, v41
    v_cvt_pk_bf16_f32 v62, v43, v43
    v_lshlrev_b32 v62, 16, v62
    v_sub_f32 v42, v55, v37
    v_cvt_pk_bf16_f32 v42, v42, v42
    v_lshlrev_b32 v42, 16, v42
    v_mul_f32 v43, v42, v41
    v_fma_f32 v44, -v43, v40, v42
    v_fmac_f32 v43, v44, v41
    v_cvt_pk_bf16_f32 v63, v43, v43
    v_lshlrev_b32 v63, 16, v63
    s_lshl_b32 s33, s32, 11
    v_lshlrev_b32 v5, 5, v1
    v_add_u32 v5, s33, v5
    ds_write_b128 v5, v[56:59] offset:0
    ds_write_b128 v5, v[60:63] offset:16
    s_lshl_b32 s34, s54, 8
    s_add_u32 s34, s34, s33
    v_lshlrev_b32 v5, 6, v3
    v_add_u32 v5, s34, v5
    s_waitcnt lgkmcnt(0)
    ds_read_b128 v[48:51], v5 offset:0
    ds_read_b128 v[52:55], v5 offset:16
    ds_read_b128 v[56:59], v5 offset:32
    ds_read_b128 v[60:63], v5 offset:48
    v_lshrrev_b32 v5, 2, v1
    v_lshlrev_b32 v5, 2, v5
    v_add_u32 v5, s34, v5
    ds_read_b32 v24, v5 offset:0
    ds_read_b32 v25, v5 offset:64
    ds_read_b32 v26, v5 offset:128
    ds_read_b32 v27, v5 offset:192
    s_waitcnt lgkmcnt(0)
    s_waitcnt vmcnt(8)
    v_lshlrev_b32 v32, 16, v192
    v_and_b32 v33, s46, v192
    v_lshlrev_b32 v34, 16, v193
    v_and_b32 v35, s46, v193
    v_lshlrev_b32 v36, 16, v194
    v_and_b32 v37, s46, v194
    v_lshlrev_b32 v38, 16, v195
    v_and_b32 v39, s46, v195
    v_mul_f32 v16, v48, v32
    v_mul_f32 v17, v48, v33
    v_mul_f32 v18, v48, v34
    v_mul_f32 v19, v48, v35
    v_mul_f32 v20, v48, v36
    v_mul_f32 v21, v48, v37
    v_mul_f32 v22, v48, v38
    v_mul_f32 v23, v48, v39
    v_lshlrev_b32 v32, 16, v196
    v_and_b32 v33, s46, v196
    v_lshlrev_b32 v34, 16, v197
    v_and_b32 v35, s46, v197
    v_lshlrev_b32 v36, 16, v198
    v_and_b32 v37, s46, v198
    v_lshlrev_b32 v38, 16, v199
    v_and_b32 v39, s46, v199
    v_fmac_f32 v16, v49, v32
    v_fmac_f32 v17, v49, v33
    v_fmac_f32 v18, v49, v34
    v_fmac_f32 v19, v49, v35
    v_fmac_f32 v20, v49, v36
    v_fmac_f32 v21, v49, v37
    v_fmac_f32 v22, v49, v38
    v_fmac_f32 v23, v49, v39
    v_lshlrev_b32 v32, 16, v200
    v_and_b32 v33, s46, v200
    v_lshlrev_b32 v34, 16, v201
    v_and_b32 v35, s46, v201
    v_lshlrev_b32 v36, 16, v202
    v_and_b32 v37, s46, v202
    v_lshlrev_b32 v38, 16, v203
    v_and_b32 v39, s46, v203
    v_fmac_f32 v16, v50, v32
    v_fmac_f32 v17, v50, v33
    v_fmac_f32 v18, v50, v34
    v_fmac_f32 v19, v50, v35
    v_fmac_f32 v20, v50, v36
    v_fmac_f32 v21, v50, v37
    v_fmac_f32 v22, v50, v38
    v_fmac_f32 v23, v50, v39
    v_lshlrev_b32 v32, 16, v204
    v_and_b32 v33, s46, v204
    v_lshlrev_b32 v34, 16, v205
    v_and_b32 v35, s46, v205
    v_lshlrev_b32 v36, 16, v206
    v_and_b32 v37, s46, v206
    v_lshlrev_b32 v38, 16, v207
    v_and_b32 v39, s46, v207
    v_fmac_f32 v16, v51, v32
    v_fmac_f32 v17, v51, v33
    v_fmac_f32 v18, v51, v34
    v_fmac_f32 v19, v51, v35
    v_fmac_f32 v20, v51, v36
    v_fmac_f32 v21, v51, v37
    v_fmac_f32 v22, v51, v38
    v_fmac_f32 v23, v51, v39
    v_lshlrev_b32 v32, 16, v208
    v_and_b32 v33, s46, v208
    v_lshlrev_b32 v34, 16, v209
    v_and_b32 v35, s46, v209
    v_lshlrev_b32 v36, 16, v210
    v_and_b32 v37, s46, v210
    v_lshlrev_b32 v38, 16, v211
    v_and_b32 v39, s46, v211
    v_fmac_f32 v16, v52, v32
    v_fmac_f32 v17, v52, v33
    v_fmac_f32 v18, v52, v34
    v_fmac_f32 v19, v52, v35
    v_fmac_f32 v20, v52, v36
    v_fmac_f32 v21, v52, v37
    v_fmac_f32 v22, v52, v38
    v_fmac_f32 v23, v52, v39
    v_lshlrev_b32 v32, 16, v212
    v_and_b32 v33, s46, v212
    v_lshlrev_b32 v34, 16, v213
    v_and_b32 v35, s46, v213
    v_lshlrev_b32 v36, 16, v214
    v_and_b32 v37, s46, v214
    v_lshlrev_b32 v38, 16, v215
    v_and_b32 v39, s46, v215
    v_fmac_f32 v16, v53, v32
    v_fmac_f32 v17, v53, v33
    v_fmac_f32 v18, v53, v34
    v_fmac_f32 v19, v53, v35
    v_fmac_f32 v20, v53, v36
    v_fmac_f32 v21, v53, v37
    v_fmac_f32 v22, v53, v38
    v_fmac_f32 v23, v53, v39
    v_lshlrev_b32 v32, 16, v216
    v_and_b32 v33, s46, v216
    v_lshlrev_b32 v34, 16, v217
    v_and_b32 v35, s46, v217
    v_lshlrev_b32 v36, 16, v218
    v_and_b32 v37, s46, v218
    v_lshlrev_b32 v38, 16, v219
    v_and_b32 v39, s46, v219
    v_fmac_f32 v16, v54, v32
    v_fmac_f32 v17, v54, v33
    v_fmac_f32 v18, v54, v34
    v_fmac_f32 v19, v54, v35
    v_fmac_f32 v20, v54, v36
    v_fmac_f32 v21, v54, v37
    v_fmac_f32 v22, v54, v38
    v_fmac_f32 v23, v54, v39
    v_lshlrev_b32 v32, 16, v220
    v_and_b32 v33, s46, v220
    v_lshlrev_b32 v34, 16, v221
    v_and_b32 v35, s46, v221
    v_lshlrev_b32 v36, 16, v222
    v_and_b32 v37, s46, v222
    v_lshlrev_b32 v38, 16, v223
    v_and_b32 v39, s46, v223
    v_fmac_f32 v16, v55, v32
    v_fmac_f32 v17, v55, v33
    v_fmac_f32 v18, v55, v34
    v_fmac_f32 v19, v55, v35
    v_fmac_f32 v20, v55, v36
    v_fmac_f32 v21, v55, v37
    v_fmac_f32 v22, v55, v38
    v_fmac_f32 v23, v55, v39
    v_lshlrev_b32 v32, 16, v224
    v_and_b32 v33, s46, v224
    v_lshlrev_b32 v34, 16, v225
    v_and_b32 v35, s46, v225
    v_lshlrev_b32 v36, 16, v226
    v_and_b32 v37, s46, v226
    v_lshlrev_b32 v38, 16, v227
    v_and_b32 v39, s46, v227
    v_fmac_f32 v16, v56, v32
    v_fmac_f32 v17, v56, v33
    v_fmac_f32 v18, v56, v34
    v_fmac_f32 v19, v56, v35
    v_fmac_f32 v20, v56, v36
    v_fmac_f32 v21, v56, v37
    v_fmac_f32 v22, v56, v38
    v_fmac_f32 v23, v56, v39
    v_lshlrev_b32 v32, 16, v228
    v_and_b32 v33, s46, v228
    v_lshlrev_b32 v34, 16, v229
    v_and_b32 v35, s46, v229
    v_lshlrev_b32 v36, 16, v230
    v_and_b32 v37, s46, v230
    v_lshlrev_b32 v38, 16, v231
    v_and_b32 v39, s46, v231
    v_fmac_f32 v16, v57, v32
    v_fmac_f32 v17, v57, v33
    v_fmac_f32 v18, v57, v34
    v_fmac_f32 v19, v57, v35
    v_fmac_f32 v20, v57, v36
    v_fmac_f32 v21, v57, v37
    v_fmac_f32 v22, v57, v38
    v_fmac_f32 v23, v57, v39
    v_lshlrev_b32 v32, 16, v232
    v_and_b32 v33, s46, v232
    v_lshlrev_b32 v34, 16, v233
    v_and_b32 v35, s46, v233
    v_lshlrev_b32 v36, 16, v234
    v_and_b32 v37, s46, v234
    v_lshlrev_b32 v38, 16, v235
    v_and_b32 v39, s46, v235
    v_fmac_f32 v16, v58, v32
    v_fmac_f32 v17, v58, v33
    v_fmac_f32 v18, v58, v34
    v_fmac_f32 v19, v58, v35
    v_fmac_f32 v20, v58, v36
    v_fmac_f32 v21, v58, v37
    v_fmac_f32 v22, v58, v38
    v_fmac_f32 v23, v58, v39
    v_lshlrev_b32 v32, 16, v236
    v_and_b32 v33, s46, v236
    v_lshlrev_b32 v34, 16, v237
    v_and_b32 v35, s46, v237
    v_lshlrev_b32 v36, 16, v238
    v_and_b32 v37, s46, v238
    v_lshlrev_b32 v38, 16, v239
    v_and_b32 v39, s46, v239
    v_fmac_f32 v16, v59, v32
    v_fmac_f32 v17, v59, v33
    v_fmac_f32 v18, v59, v34
    v_fmac_f32 v19, v59, v35
    v_fmac_f32 v20, v59, v36
    v_fmac_f32 v21, v59, v37
    v_fmac_f32 v22, v59, v38
    v_fmac_f32 v23, v59, v39
    v_lshlrev_b32 v32, 16, v240
    v_and_b32 v33, s46, v240
    v_lshlrev_b32 v34, 16, v241
    v_and_b32 v35, s46, v241
    v_lshlrev_b32 v36, 16, v242
    v_and_b32 v37, s46, v242
    v_lshlrev_b32 v38, 16, v243
    v_and_b32 v39, s46, v243
    v_fmac_f32 v16, v60, v32
    v_fmac_f32 v17, v60, v33
    v_fmac_f32 v18, v60, v34
    v_fmac_f32 v19, v60, v35
    v_fmac_f32 v20, v60, v36
    v_fmac_f32 v21, v60, v37
    v_fmac_f32 v22, v60, v38
    v_fmac_f32 v23, v60, v39
    v_lshlrev_b32 v32, 16, v244
    v_and_b32 v33, s46, v244
    v_lshlrev_b32 v34, 16, v245
    v_and_b32 v35, s46, v245
    v_lshlrev_b32 v36, 16, v246
    v_and_b32 v37, s46, v246
    v_lshlrev_b32 v38, 16, v247
    v_and_b32 v39, s46, v247
    v_fmac_f32 v16, v61, v32
    v_fmac_f32 v17, v61, v33
    v_fmac_f32 v18, v61, v34
    v_fmac_f32 v19, v61, v35
    v_fmac_f32 v20, v61, v36
    v_fmac_f32 v21, v61, v37
    v_fmac_f32 v22, v61, v38
    v_fmac_f32 v23, v61, v39
    v_lshlrev_b32 v32, 16, v248
    v_and_b32 v33, s46, v248
    v_lshlrev_b32 v34, 16, v249
    v_and_b32 v35, s46, v249
    v_lshlrev_b32 v36, 16, v250
    v_and_b32 v37, s46, v250
    v_lshlrev_b32 v38, 16, v251
    v_and_b32 v39, s46, v251
    v_fmac_f32 v16, v62, v32
    v_fmac_f32 v17, v62, v33
    v_fmac_f32 v18, v62, v34
    v_fmac_f32 v19, v62, v35
    v_fmac_f32 v20, v62, v36
    v_fmac_f32 v21, v62, v37
    v_fmac_f32 v22, v62, v38
    v_fmac_f32 v23, v62, v39
    v_lshlrev_b32 v32, 16, v252
    v_and_b32 v33, s46, v252
    v_lshlrev_b32 v34, 16, v253
    v_and_b32 v35, s46, v253
    v_lshlrev_b32 v36, 16, v254
    v_and_b32 v37, s46, v254
    v_lshlrev_b32 v38, 16, v255
    v_and_b32 v39, s46, v255
    v_fmac_f32 v16, v63, v32
    v_fmac_f32 v17, v63, v33
    v_fmac_f32 v18, v63, v34
    v_fmac_f32 v19, v63, v35
    v_fmac_f32 v20, v63, v36
    v_fmac_f32 v21, v63, v37
    v_fmac_f32 v22, v63, v38
    v_fmac_f32 v23, v63, v39
    v_lshlrev_b32 v5, 5, v0
    ds_write_b128 v5, v[16:19] offset:16384
    ds_write_b128 v5, v[20:23] offset:16400
    v_and_b32 v5, 127, v0
    v_lshrrev_b32 v7, 7, v0
    v_lshlrev_b32 v5, 2, v5
    v_lshl_add_u32 v5, v7, 12, v5
    global_load_dwordx4 v[128:131], v4, s[36:37] offset:0 nt
    global_load_dwordx4 v[132:135], v4, s[36:37] offset:256 nt
    global_load_dwordx4 v[136:139], v4, s[36:37] offset:512 nt
    global_load_dwordx4 v[140:143], v4, s[36:37] offset:768 nt
    global_load_dwordx4 v[144:147], v4, s[36:37] offset:1024 nt
    global_load_dwordx4 v[148:151], v4, s[36:37] offset:1280 nt
    global_load_dwordx4 v[152:155], v4, s[36:37] offset:1536 nt
    global_load_dwordx4 v[156:159], v4, s[36:37] offset:1792 nt
    s_waitcnt lgkmcnt(0)
    s_barrier
    ds_read_b32 v32, v5 offset:16384
    ds_read_b32 v33, v5 offset:16896
    ds_read_b32 v34, v5 offset:17408
    ds_read_b32 v35, v5 offset:17920
    ds_read_b32 v36, v5 offset:18432
    ds_read_b32 v37, v5 offset:18944
    ds_read_b32 v38, v5 offset:19456
    ds_read_b32 v39, v5 offset:19968
    v_lshlrev_b32 v5, 2, v0
    s_waitcnt lgkmcnt(0)
    v_add_f32 v32, v32, v33
    v_add_f32 v34, v34, v35
    v_add_f32 v36, v36, v37
    v_add_f32 v38, v38, v39
    v_add_f32 v32, v32, v34
    v_add_f32 v36, v36, v38
    v_add_f32 v32, v32, v36
    ds_write_b32 v5, v32 offset:32768
    v_lshlrev_b32 v5, 5, v2
    global_load_dwordx4 v[160:163], v4, s[38:39] offset:0 nt
    global_load_dwordx4 v[164:167], v4, s[38:39] offset:256 nt
    global_load_dwordx4 v[168:171], v4, s[38:39] offset:512 nt
    global_load_dwordx4 v[172:175], v4, s[38:39] offset:768 nt
    global_load_dwordx4 v[176:179], v4, s[38:39] offset:1024 nt
    global_load_dwordx4 v[180:183], v4, s[38:39] offset:1280 nt
    global_load_dwordx4 v[184:187], v4, s[38:39] offset:1536 nt
    global_load_dwordx4 v[188:191], v4, s[38:39] offset:1792 nt
    v_add_u32 v4, 65536, v4
    s_waitcnt lgkmcnt(0)
    s_barrier
    ds_read_b128 v[32:35], v5 offset:32768
    ds_read_b128 v[36:39], v5 offset:32784
    ds_read_b128 v[40:43], v5 offset:33280
    ds_read_b128 v[44:47], v5 offset:33296
    ds_read_b128 v[48:51], v5 offset:33792
    ds_read_b128 v[52:55], v5 offset:33808
    ds_read_b128 v[56:59], v5 offset:34304
    ds_read_b128 v[60:63], v5 offset:34320
    s_waitcnt lgkmcnt(0)
    v_add_f32 v32, v32, v40
    v_add_f32 v48, v48, v56
    v_add_f32 v33, v33, v41
    v_add_f32 v49, v49, v57
    v_add_f32 v34, v34, v42
    v_add_f32 v50, v50, v58
    v_add_f32 v35, v35, v43
    v_add_f32 v51, v51, v59
    v_add_f32 v36, v36, v44
    v_add_f32 v52, v52, v60
    v_add_f32 v37, v37, v45
    v_add_f32 v53, v53, v61
    v_add_f32 v38, v38, v46
    v_add_f32 v54, v54, v62
    v_add_f32 v39, v39, v47
    v_add_f32 v55, v55, v63
    v_add_f32 v32, v32, v48
    v_add_f32 v33, v33, v49
    v_add_f32 v34, v34, v50
    v_add_f32 v35, v35, v51
    v_add_f32 v36, v36, v52
    v_add_f32 v37, v37, v53
    v_add_f32 v38, v38, v54
    v_add_f32 v39, v39, v55
    v_cvt_pk_bf16_f32 v8, v32, v33
    v_cvt_pk_bf16_f32 v9, v34, v35
    v_cvt_pk_bf16_f32 v10, v36, v37
    v_cvt_pk_bf16_f32 v11, v38, v39
    s_min_u32 s42, s31, 55
    s_lshl_b32 s33, s42, 6
    s_add_u32 s34, s16, s33
    s_addc_u32 s35, s17, 0
    s_add_u32 s40, s18, s33
    s_addc_u32 s41, s19, 0
    s_lshl_b32 s33, s54, 6
    v_lshrrev_b32 v7, 2, v1
    v_add_u32 v7, s33, v7
    v_mul_u32_u24 v7, 3584, v7
    v_and_b32 v5, 3, v1
    v_lshl_add_u32 v7, v5, 4, v7
    global_load_dwordx4 v[192:195], v7, s[34:35]
    global_load_dwordx4 v[208:211], v7, s[40:41]
    v_add_u32 v7, 57344, v7
    global_load_dwordx4 v[196:199], v7, s[34:35]
    global_load_dwordx4 v[212:215], v7, s[40:41]
    v_add_u32 v7, 57344, v7
    global_load_dwordx4 v[200:203], v7, s[34:35]
    global_load_dwordx4 v[216:219], v7, s[40:41]
    v_add_u32 v7, 57344, v7
    global_load_dwordx4 v[204:207], v7, s[34:35]
    global_load_dwordx4 v[220:223], v7, s[40:41]
    s_lshl_b32 s33, s42, 15
    s_add_u32 s34, s20, s33
    s_addc_u32 s35, s21, 0
    s_lshl_b32 s33, s54, 12
    v_add_u32 v7, s33, v6
    global_load_dwordx4 v[224:227], v7, s[34:35] offset:0
    global_load_dwordx4 v[228:231], v7, s[34:35] offset:1024
    global_load_dwordx4 v[232:235], v7, s[34:35] offset:2048
    global_load_dwordx4 v[236:239], v7, s[34:35] offset:3072
    v_mov_b32 v12, 0xff800000
    v_mov_b32 v13, 0
    v_mov_b32 v14, 0xff800000
    v_mov_b32 v16, 0
    v_mov_b32 v17, 0
    v_mov_b32 v18, 0
    v_mov_b32 v19, 0
    v_mov_b32 v20, 0
    v_mov_b32 v21, 0
    v_mov_b32 v22, 0
    v_mov_b32 v23, 0
    v_dot2_f32_bf16 v24, v64, v8, 0
    v_dot2_f32_bf16 v25, v68, v8, 0
    v_dot2_f32_bf16 v26, v72, v8, 0
    v_dot2_f32_bf16 v27, v76, v8, 0
    v_dot2_f32_bf16 v28, v80, v8, 0
    v_dot2_f32_bf16 v29, v84, v8, 0
    v_dot2_f32_bf16 v30, v88, v8, 0
    v_dot2_f32_bf16 v31, v92, v8, 0
    v_dot2_f32_bf16 v24, v65, v9, v24
    v_dot2_f32_bf16 v25, v69, v9, v25
    v_dot2_f32_bf16 v26, v73, v9, v26
    v_dot2_f32_bf16 v27, v77, v9, v27
    v_dot2_f32_bf16 v28, v81, v9, v28
    v_dot2_f32_bf16 v29, v85, v9, v29
    v_dot2_f32_bf16 v30, v89, v9, v30
    v_dot2_f32_bf16 v31, v93, v9, v31
    v_dot2_f32_bf16 v24, v66, v10, v24
    v_dot2_f32_bf16 v25, v70, v10, v25
    v_dot2_f32_bf16 v26, v74, v10, v26
    v_dot2_f32_bf16 v27, v78, v10, v27
    v_dot2_f32_bf16 v28, v82, v10, v28
    v_dot2_f32_bf16 v29, v86, v10, v29
    v_dot2_f32_bf16 v30, v90, v10, v30
    v_dot2_f32_bf16 v31, v94, v10, v31
    v_dot2_f32_bf16 v24, v67, v11, v24
    v_dot2_f32_bf16 v25, v71, v11, v25
    v_dot2_f32_bf16 v26, v75, v11, v26
    v_dot2_f32_bf16 v27, v79, v11, v27
    v_dot2_f32_bf16 v28, v83, v11, v28
    v_dot2_f32_bf16 v29, v87, v11, v29
    v_dot2_f32_bf16 v30, v91, v11, v30
    v_dot2_f32_bf16 v31, v95, v11, v31
    global_load_dwordx4 v[64:67], v4, s[36:37] offset:0 nt
    global_load_dwordx4 v[68:71], v4, s[36:37] offset:256 nt
    global_load_dwordx4 v[72:75], v4, s[36:37] offset:512 nt
    global_load_dwordx4 v[76:79], v4, s[36:37] offset:768 nt
    global_load_dwordx4 v[80:83], v4, s[36:37] offset:1024 nt
    global_load_dwordx4 v[84:87], v4, s[36:37] offset:1280 nt
    global_load_dwordx4 v[88:91], v4, s[36:37] offset:1536 nt
    global_load_dwordx4 v[92:95], v4, s[36:37] offset:1792 nt
    v_add_f32_dpp v24, v24, v24 row_ror:8 row_mask:0xf bank_mask:0xf
    v_add_f32_dpp v25, v25, v25 row_ror:8 row_mask:0xf bank_mask:0xf
    v_add_f32_dpp v26, v26, v26 row_ror:8 row_mask:0xf bank_mask:0xf
    v_add_f32_dpp v27, v27, v27 row_ror:8 row_mask:0xf bank_mask:0xf
    v_add_f32_dpp v28, v28, v28 row_ror:8 row_mask:0xf bank_mask:0xf
    v_add_f32_dpp v29, v29, v29 row_ror:8 row_mask:0xf bank_mask:0xf
    v_add_f32_dpp v30, v30, v30 row_ror:8 row_mask:0xf bank_mask:0xf
    v_add_f32_dpp v31, v31, v31 row_ror:8 row_mask:0xf bank_mask:0xf
    v_add_f32_dpp v24, v24, v24 row_ror:4 row_mask:0xf bank_mask:0xf
    v_add_f32_dpp v25, v25, v25 row_ror:4 row_mask:0xf bank_mask:0xf
    v_add_f32_dpp v26, v26, v26 row_ror:4 row_mask:0xf bank_mask:0xf
    v_add_f32_dpp v27, v27, v27 row_ror:4 row_mask:0xf bank_mask:0xf
    v_add_f32_dpp v28, v28, v28 row_ror:4 row_mask:0xf bank_mask:0xf
    v_add_f32_dpp v29, v29, v29 row_ror:4 row_mask:0xf bank_mask:0xf
    v_add_f32_dpp v30, v30, v30 row_ror:4 row_mask:0xf bank_mask:0xf
    v_add_f32_dpp v31, v31, v31 row_ror:4 row_mask:0xf bank_mask:0xf
    v_add_f32_dpp v24, v24, v24 row_ror:2 row_mask:0xf bank_mask:0xf
    v_add_f32_dpp v25, v25, v25 row_ror:2 row_mask:0xf bank_mask:0xf
    v_add_f32_dpp v26, v26, v26 row_ror:2 row_mask:0xf bank_mask:0xf
    v_add_f32_dpp v27, v27, v27 row_ror:2 row_mask:0xf bank_mask:0xf
    v_add_f32_dpp v28, v28, v28 row_ror:2 row_mask:0xf bank_mask:0xf
    v_add_f32_dpp v29, v29, v29 row_ror:2 row_mask:0xf bank_mask:0xf
    v_add_f32_dpp v30, v30, v30 row_ror:2 row_mask:0xf bank_mask:0xf
    v_add_f32_dpp v31, v31, v31 row_ror:2 row_mask:0xf bank_mask:0xf
    v_add_f32_dpp v24, v24, v24 row_ror:1 row_mask:0xf bank_mask:0xf
    v_add_f32_dpp v25, v25, v25 row_ror:1 row_mask:0xf bank_mask:0xf
    v_add_f32_dpp v26, v26, v26 row_ror:1 row_mask:0xf bank_mask:0xf
    v_add_f32_dpp v27, v27, v27 row_ror:1 row_mask:0xf bank_mask:0xf
    v_add_f32_dpp v28, v28, v28 row_ror:1 row_mask:0xf bank_mask:0xf
    v_add_f32_dpp v29, v29, v29 row_ror:1 row_mask:0xf bank_mask:0xf
    v_add_f32_dpp v30, v30, v30 row_ror:1 row_mask:0xf bank_mask:0xf
    v_add_f32_dpp v31, v31, v31 row_ror:1 row_mask:0xf bank_mask:0xf
    v_cvt_pk_bf16_f32 v32, v24, v25
    v_cvt_pk_bf16_f32 v33, v26, v27
    v_cvt_pk_bf16_f32 v34, v28, v29
    v_cvt_pk_bf16_f32 v35, v30, v31
    v_lshlrev_b32 v24, 16, v32
    v_and_b32 v25, s46, v32
    v_lshlrev_b32 v26, 16, v33
    v_and_b32 v27, s46, v33
    v_lshlrev_b32 v28, 16, v34
    v_and_b32 v29, s46, v34
    v_lshlrev_b32 v30, 16, v35
    v_and_b32 v31, s46, v35
    v_mul_f32 v24, s44, v24
    v_mul_f32 v25, s44, v25
    v_mul_f32 v26, s44, v26
    v_mul_f32 v27, s44, v27
    v_mul_f32 v28, s44, v28
    v_mul_f32 v29, s44, v29
    v_mul_f32 v30, s44, v30
    v_mul_f32 v31, s44, v31
    v_cvt_pk_bf16_f32 v32, v24, v25
    v_cvt_pk_bf16_f32 v33, v26, v27
    v_cvt_pk_bf16_f32 v34, v28, v29
    v_cvt_pk_bf16_f32 v35, v30, v31
    v_lshlrev_b32 v24, 16, v32
    v_and_b32 v25, s46, v32
    v_lshlrev_b32 v26, 16, v33
    v_and_b32 v27, s46, v33
    v_lshlrev_b32 v28, 16, v34
    v_and_b32 v29, s46, v34
    v_lshlrev_b32 v30, 16, v35
    v_and_b32 v31, s46, v35
    v_max3_f32 v32, v24, v25, v26
    v_max3_f32 v33, v27, v28, v29
    v_max3_f32 v34, v30, v31, v12
    v_max3_f32 v12, v32, v33, v34
    v_mul_f32 v15, s45, v12
    v_sub_f32 v35, v14, v15
    v_exp_f32 v35, v35
    v_mov_b32 v14, v15
    v_fma_f32 v24, v24, s45, -v15
    v_fma_f32 v25, v25, s45, -v15
    v_fma_f32 v26, v26, s45, -v15
    v_fma_f32 v27, v27, s45, -v15
    v_fma_f32 v28, v28, s45, -v15
    v_fma_f32 v29, v29, s45, -v15
    v_fma_f32 v30, v30, s45, -v15
    v_fma_f32 v31, v31, s45, -v15
    v_exp_f32 v24, v24
    v_exp_f32 v25, v25
    v_exp_f32 v26, v26
    v_exp_f32 v27, v27
    v_exp_f32 v28, v28
    v_exp_f32 v29, v29
    v_exp_f32 v30, v30
    v_exp_f32 v31, v31
    v_mul_f32 v13, v13, v35
    v_mul_f32 v16, v16, v35
    v_mul_f32 v17, v17, v35
    v_mul_f32 v18, v18, v35
    v_mul_f32 v19, v19, v35
    v_mul_f32 v20, v20, v35
    v_mul_f32 v21, v21, v35
    v_mul_f32 v22, v22, v35
    v_mul_f32 v23, v23, v35
    v_add_f32 v36, v24, v25
    v_add_f32 v37, v26, v27
    v_add_f32 v38, v28, v29
    v_add_f32 v39, v30, v31
    v_add_f32 v36, v36, v37
    v_add_f32 v38, v38, v39
    v_add_f32 v36, v36, v38
    v_add_f32 v13, v13, v36
    s_waitcnt vmcnt(36)
    v_lshlrev_b32 v32, 16, v96
    v_and_b32 v33, s46, v96
    v_lshlrev_b32 v34, 16, v97
    v_and_b32 v35, s46, v97
    v_lshlrev_b32 v36, 16, v98
    v_and_b32 v37, s46, v98
    v_lshlrev_b32 v38, 16, v99
    v_and_b32 v39, s46, v99
    v_fmac_f32 v16, v24, v32
    v_fmac_f32 v17, v24, v33
    v_fmac_f32 v18, v24, v34
    v_fmac_f32 v19, v24, v35
    v_fmac_f32 v20, v24, v36
    v_fmac_f32 v21, v24, v37
    v_fmac_f32 v22, v24, v38
    v_fmac_f32 v23, v24, v39
    v_lshlrev_b32 v40, 16, v100
    v_and_b32 v41, s46, v100
    v_lshlrev_b32 v42, 16, v101
    v_and_b32 v43, s46, v101
    v_lshlrev_b32 v44, 16, v102
    v_and_b32 v45, s46, v102
    v_lshlrev_b32 v46, 16, v103
    v_and_b32 v47, s46, v103
    v_fmac_f32 v16, v25, v40
    v_fmac_f32 v17, v25, v41
    v_fmac_f32 v18, v25, v42
    v_fmac_f32 v19, v25, v43
    v_fmac_f32 v20, v25, v44
    v_fmac_f32 v21, v25, v45
    v_fmac_f32 v22, v25, v46
    v_fmac_f32 v23, v25, v47
    v_lshlrev_b32 v32, 16, v104
    v_and_b32 v33, s46, v104
    v_lshlrev_b32 v34, 16, v105
    v_and_b32 v35, s46, v105
    v_lshlrev_b32 v36, 16, v106
    v_and_b32 v37, s46, v106
    v_lshlrev_b32 v38, 16, v107
    v_and_b32 v39, s46, v107
    v_fmac_f32 v16, v26, v32
    v_fmac_f32 v17, v26, v33
    v_fmac_f32 v18, v26, v34
    v_fmac_f32 v19, v26, v35
    v_fmac_f32 v20, v26, v36
    v_fmac_f32 v21, v26, v37
    v_fmac_f32 v22, v26, v38
    v_fmac_f32 v23, v26, v39
    v_lshlrev_b32 v40, 16, v108
    v_and_b32 v41, s46, v108
    v_lshlrev_b32 v42, 16, v109
    v_and_b32 v43, s46, v109
    v_lshlrev_b32 v44, 16, v110
    v_and_b32 v45, s46, v110
    v_lshlrev_b32 v46, 16, v111
    v_and_b32 v47, s46, v111
    v_fmac_f32 v16, v27, v40
    v_fmac_f32 v17, v27, v41
    v_fmac_f32 v18, v27, v42
    v_fmac_f32 v19, v27, v43
    v_fmac_f32 v20, v27, v44
    v_fmac_f32 v21, v27, v45
    v_fmac_f32 v22, v27, v46
    v_fmac_f32 v23, v27, v47
    v_lshlrev_b32 v32, 16, v112
    v_and_b32 v33, s46, v112
    v_lshlrev_b32 v34, 16, v113
    v_and_b32 v35, s46, v113
    v_lshlrev_b32 v36, 16, v114
    v_and_b32 v37, s46, v114
    v_lshlrev_b32 v38, 16, v115
    v_and_b32 v39, s46, v115
    v_fmac_f32 v16, v28, v32
    v_fmac_f32 v17, v28, v33
    v_fmac_f32 v18, v28, v34
    v_fmac_f32 v19, v28, v35
    v_fmac_f32 v20, v28, v36
    v_fmac_f32 v21, v28, v37
    v_fmac_f32 v22, v28, v38
    v_fmac_f32 v23, v28, v39
    v_lshlrev_b32 v40, 16, v116
    v_and_b32 v41, s46, v116
    v_lshlrev_b32 v42, 16, v117
    v_and_b32 v43, s46, v117
    v_lshlrev_b32 v44, 16, v118
    v_and_b32 v45, s46, v118
    v_lshlrev_b32 v46, 16, v119
    v_and_b32 v47, s46, v119
    v_fmac_f32 v16, v29, v40
    v_fmac_f32 v17, v29, v41
    v_fmac_f32 v18, v29, v42
    v_fmac_f32 v19, v29, v43
    v_fmac_f32 v20, v29, v44
    v_fmac_f32 v21, v29, v45
    v_fmac_f32 v22, v29, v46
    v_fmac_f32 v23, v29, v47
    v_lshlrev_b32 v32, 16, v120
    v_and_b32 v33, s46, v120
    v_lshlrev_b32 v34, 16, v121
    v_and_b32 v35, s46, v121
    v_lshlrev_b32 v36, 16, v122
    v_and_b32 v37, s46, v122
    v_lshlrev_b32 v38, 16, v123
    v_and_b32 v39, s46, v123
    v_fmac_f32 v16, v30, v32
    v_fmac_f32 v17, v30, v33
    v_fmac_f32 v18, v30, v34
    v_fmac_f32 v19, v30, v35
    v_fmac_f32 v20, v30, v36
    v_fmac_f32 v21, v30, v37
    v_fmac_f32 v22, v30, v38
    v_fmac_f32 v23, v30, v39
    v_lshlrev_b32 v40, 16, v124
    v_and_b32 v41, s46, v124
    v_lshlrev_b32 v42, 16, v125
    v_and_b32 v43, s46, v125
    v_lshlrev_b32 v44, 16, v126
    v_and_b32 v45, s46, v126
    v_lshlrev_b32 v46, 16, v127
    v_and_b32 v47, s46, v127
    v_fmac_f32 v16, v31, v40
    v_fmac_f32 v17, v31, v41
    v_fmac_f32 v18, v31, v42
    v_fmac_f32 v19, v31, v43
    v_fmac_f32 v20, v31, v44
    v_fmac_f32 v21, v31, v45
    v_fmac_f32 v22, v31, v46
    v_fmac_f32 v23, v31, v47
    global_load_dwordx4 v[96:99], v4, s[38:39] offset:0 nt
    global_load_dwordx4 v[100:103], v4, s[38:39] offset:256 nt
    global_load_dwordx4 v[104:107], v4, s[38:39] offset:512 nt
    global_load_dwordx4 v[108:111], v4, s[38:39] offset:768 nt
    global_load_dwordx4 v[112:115], v4, s[38:39] offset:1024 nt
    global_load_dwordx4 v[116:119], v4, s[38:39] offset:1280 nt
    global_load_dwordx4 v[120:123], v4, s[38:39] offset:1536 nt
    global_load_dwordx4 v[124:127], v4, s[38:39] offset:1792 nt
    v_add_u32 v4, 65536, v4
    s_waitcnt vmcnt(36)
    v_dot2_f32_bf16 v24, v128, v8, 0
    v_dot2_f32_bf16 v25, v132, v8, 0
    v_dot2_f32_bf16 v26, v136, v8, 0
    v_dot2_f32_bf16 v27, v140, v8, 0
    v_dot2_f32_bf16 v28, v144, v8, 0
    v_dot2_f32_bf16 v29, v148, v8, 0
    v_dot2_f32_bf16 v30, v152, v8, 0
    v_dot2_f32_bf16 v31, v156, v8, 0
    v_dot2_f32_bf16 v24, v129, v9, v24
    v_dot2_f32_bf16 v25, v133, v9, v25
    v_dot2_f32_bf16 v26, v137, v9, v26
    v_dot2_f32_bf16 v27, v141, v9, v27
    v_dot2_f32_bf16 v28, v145, v9, v28
    v_dot2_f32_bf16 v29, v149, v9, v29
    v_dot2_f32_bf16 v30, v153, v9, v30
    v_dot2_f32_bf16 v31, v157, v9, v31
    v_dot2_f32_bf16 v24, v130, v10, v24
    v_dot2_f32_bf16 v25, v134, v10, v25
    v_dot2_f32_bf16 v26, v138, v10, v26
    v_dot2_f32_bf16 v27, v142, v10, v27
    v_dot2_f32_bf16 v28, v146, v10, v28
    v_dot2_f32_bf16 v29, v150, v10, v29
    v_dot2_f32_bf16 v30, v154, v10, v30
    v_dot2_f32_bf16 v31, v158, v10, v31
    v_dot2_f32_bf16 v24, v131, v11, v24
    v_dot2_f32_bf16 v25, v135, v11, v25
    v_dot2_f32_bf16 v26, v139, v11, v26
    v_dot2_f32_bf16 v27, v143, v11, v27
    v_dot2_f32_bf16 v28, v147, v11, v28
    v_dot2_f32_bf16 v29, v151, v11, v29
    v_dot2_f32_bf16 v30, v155, v11, v30
    v_dot2_f32_bf16 v31, v159, v11, v31
    global_load_dwordx4 v[128:131], v4, s[36:37] offset:0 nt
    global_load_dwordx4 v[132:135], v4, s[36:37] offset:256 nt
    global_load_dwordx4 v[136:139], v4, s[36:37] offset:512 nt
    global_load_dwordx4 v[140:143], v4, s[36:37] offset:768 nt
    global_load_dwordx4 v[144:147], v4, s[36:37] offset:1024 nt
    global_load_dwordx4 v[148:151], v4, s[36:37] offset:1280 nt
    global_load_dwordx4 v[152:155], v4, s[36:37] offset:1536 nt
    global_load_dwordx4 v[156:159], v4, s[36:37] offset:1792 nt
    v_add_f32_dpp v24, v24, v24 row_ror:8 row_mask:0xf bank_mask:0xf
    v_add_f32_dpp v25, v25, v25 row_ror:8 row_mask:0xf bank_mask:0xf
    v_add_f32_dpp v26, v26, v26 row_ror:8 row_mask:0xf bank_mask:0xf
    v_add_f32_dpp v27, v27, v27 row_ror:8 row_mask:0xf bank_mask:0xf
    v_add_f32_dpp v28, v28, v28 row_ror:8 row_mask:0xf bank_mask:0xf
    v_add_f32_dpp v29, v29, v29 row_ror:8 row_mask:0xf bank_mask:0xf
    v_add_f32_dpp v30, v30, v30 row_ror:8 row_mask:0xf bank_mask:0xf
    v_add_f32_dpp v31, v31, v31 row_ror:8 row_mask:0xf bank_mask:0xf
    v_add_f32_dpp v24, v24, v24 row_ror:4 row_mask:0xf bank_mask:0xf
    v_add_f32_dpp v25, v25, v25 row_ror:4 row_mask:0xf bank_mask:0xf
    v_add_f32_dpp v26, v26, v26 row_ror:4 row_mask:0xf bank_mask:0xf
    v_add_f32_dpp v27, v27, v27 row_ror:4 row_mask:0xf bank_mask:0xf
    v_add_f32_dpp v28, v28, v28 row_ror:4 row_mask:0xf bank_mask:0xf
    v_add_f32_dpp v29, v29, v29 row_ror:4 row_mask:0xf bank_mask:0xf
    v_add_f32_dpp v30, v30, v30 row_ror:4 row_mask:0xf bank_mask:0xf
    v_add_f32_dpp v31, v31, v31 row_ror:4 row_mask:0xf bank_mask:0xf
    v_add_f32_dpp v24, v24, v24 row_ror:2 row_mask:0xf bank_mask:0xf
    v_add_f32_dpp v25, v25, v25 row_ror:2 row_mask:0xf bank_mask:0xf
    v_add_f32_dpp v26, v26, v26 row_ror:2 row_mask:0xf bank_mask:0xf
    v_add_f32_dpp v27, v27, v27 row_ror:2 row_mask:0xf bank_mask:0xf
    v_add_f32_dpp v28, v28, v28 row_ror:2 row_mask:0xf bank_mask:0xf
    v_add_f32_dpp v29, v29, v29 row_ror:2 row_mask:0xf bank_mask:0xf
    v_add_f32_dpp v30, v30, v30 row_ror:2 row_mask:0xf bank_mask:0xf
    v_add_f32_dpp v31, v31, v31 row_ror:2 row_mask:0xf bank_mask:0xf
    v_add_f32_dpp v24, v24, v24 row_ror:1 row_mask:0xf bank_mask:0xf
    v_add_f32_dpp v25, v25, v25 row_ror:1 row_mask:0xf bank_mask:0xf
    v_add_f32_dpp v26, v26, v26 row_ror:1 row_mask:0xf bank_mask:0xf
    v_add_f32_dpp v27, v27, v27 row_ror:1 row_mask:0xf bank_mask:0xf
    v_add_f32_dpp v28, v28, v28 row_ror:1 row_mask:0xf bank_mask:0xf
    v_add_f32_dpp v29, v29, v29 row_ror:1 row_mask:0xf bank_mask:0xf
    v_add_f32_dpp v30, v30, v30 row_ror:1 row_mask:0xf bank_mask:0xf
    v_add_f32_dpp v31, v31, v31 row_ror:1 row_mask:0xf bank_mask:0xf
    v_cvt_pk_bf16_f32 v32, v24, v25
    v_cvt_pk_bf16_f32 v33, v26, v27
    v_cvt_pk_bf16_f32 v34, v28, v29
    v_cvt_pk_bf16_f32 v35, v30, v31
    v_lshlrev_b32 v24, 16, v32
    v_and_b32 v25, s46, v32
    v_lshlrev_b32 v26, 16, v33
    v_and_b32 v27, s46, v33
    v_lshlrev_b32 v28, 16, v34
    v_and_b32 v29, s46, v34
    v_lshlrev_b32 v30, 16, v35
    v_and_b32 v31, s46, v35
    v_mul_f32 v24, s44, v24
    v_mul_f32 v25, s44, v25
    v_mul_f32 v26, s44, v26
    v_mul_f32 v27, s44, v27
    v_mul_f32 v28, s44, v28
    v_mul_f32 v29, s44, v29
    v_mul_f32 v30, s44, v30
    v_mul_f32 v31, s44, v31
    v_cvt_pk_bf16_f32 v32, v24, v25
    v_cvt_pk_bf16_f32 v33, v26, v27
    v_cvt_pk_bf16_f32 v34, v28, v29
    v_cvt_pk_bf16_f32 v35, v30, v31
    v_lshlrev_b32 v24, 16, v32
    v_and_b32 v25, s46, v32
    v_lshlrev_b32 v26, 16, v33
    v_and_b32 v27, s46, v33
    v_lshlrev_b32 v28, 16, v34
    v_and_b32 v29, s46, v34
    v_lshlrev_b32 v30, 16, v35
    v_and_b32 v31, s46, v35
    v_max3_f32 v32, v24, v25, v26
    v_max3_f32 v33, v27, v28, v29
    v_max3_f32 v34, v30, v31, v12
    v_max3_f32 v12, v32, v33, v34
    v_mul_f32 v15, s45, v12
    v_sub_f32 v35, v14, v15
    v_exp_f32 v35, v35
    v_mov_b32 v14, v15
    v_fma_f32 v24, v24, s45, -v15
    v_fma_f32 v25, v25, s45, -v15
    v_fma_f32 v26, v26, s45, -v15
    v_fma_f32 v27, v27, s45, -v15
    v_fma_f32 v28, v28, s45, -v15
    v_fma_f32 v29, v29, s45, -v15
    v_fma_f32 v30, v30, s45, -v15
    v_fma_f32 v31, v31, s45, -v15
    v_exp_f32 v24, v24
    v_exp_f32 v25, v25
    v_exp_f32 v26, v26
    v_exp_f32 v27, v27
    v_exp_f32 v28, v28
    v_exp_f32 v29, v29
    v_exp_f32 v30, v30
    v_exp_f32 v31, v31
    v_mul_f32 v13, v13, v35
    v_mul_f32 v16, v16, v35
    v_mul_f32 v17, v17, v35
    v_mul_f32 v18, v18, v35
    v_mul_f32 v19, v19, v35
    v_mul_f32 v20, v20, v35
    v_mul_f32 v21, v21, v35
    v_mul_f32 v22, v22, v35
    v_mul_f32 v23, v23, v35
    v_add_f32 v36, v24, v25
    v_add_f32 v37, v26, v27
    v_add_f32 v38, v28, v29
    v_add_f32 v39, v30, v31
    v_add_f32 v36, v36, v37
    v_add_f32 v38, v38, v39
    v_add_f32 v36, v36, v38
    v_add_f32 v13, v13, v36
    s_waitcnt vmcnt(36)
    v_lshlrev_b32 v32, 16, v160
    v_and_b32 v33, s46, v160
    v_lshlrev_b32 v34, 16, v161
    v_and_b32 v35, s46, v161
    v_lshlrev_b32 v36, 16, v162
    v_and_b32 v37, s46, v162
    v_lshlrev_b32 v38, 16, v163
    v_and_b32 v39, s46, v163
    v_fmac_f32 v16, v24, v32
    v_fmac_f32 v17, v24, v33
    v_fmac_f32 v18, v24, v34
    v_fmac_f32 v19, v24, v35
    v_fmac_f32 v20, v24, v36
    v_fmac_f32 v21, v24, v37
    v_fmac_f32 v22, v24, v38
    v_fmac_f32 v23, v24, v39
    v_lshlrev_b32 v40, 16, v164
    v_and_b32 v41, s46, v164
    v_lshlrev_b32 v42, 16, v165
    v_and_b32 v43, s46, v165
    v_lshlrev_b32 v44, 16, v166
    v_and_b32 v45, s46, v166
    v_lshlrev_b32 v46, 16, v167
    v_and_b32 v47, s46, v167
    v_fmac_f32 v16, v25, v40
    v_fmac_f32 v17, v25, v41
    v_fmac_f32 v18, v25, v42
    v_fmac_f32 v19, v25, v43
    v_fmac_f32 v20, v25, v44
    v_fmac_f32 v21, v25, v45
    v_fmac_f32 v22, v25, v46
    v_fmac_f32 v23, v25, v47
    v_lshlrev_b32 v32, 16, v168
    v_and_b32 v33, s46, v168
    v_lshlrev_b32 v34, 16, v169
    v_and_b32 v35, s46, v169
    v_lshlrev_b32 v36, 16, v170
    v_and_b32 v37, s46, v170
    v_lshlrev_b32 v38, 16, v171
    v_and_b32 v39, s46, v171
    v_fmac_f32 v16, v26, v32
    v_fmac_f32 v17, v26, v33
    v_fmac_f32 v18, v26, v34
    v_fmac_f32 v19, v26, v35
    v_fmac_f32 v20, v26, v36
    v_fmac_f32 v21, v26, v37
    v_fmac_f32 v22, v26, v38
    v_fmac_f32 v23, v26, v39
    v_lshlrev_b32 v40, 16, v172
    v_and_b32 v41, s46, v172
    v_lshlrev_b32 v42, 16, v173
    v_and_b32 v43, s46, v173
    v_lshlrev_b32 v44, 16, v174
    v_and_b32 v45, s46, v174
    v_lshlrev_b32 v46, 16, v175
    v_and_b32 v47, s46, v175
    v_fmac_f32 v16, v27, v40
    v_fmac_f32 v17, v27, v41
    v_fmac_f32 v18, v27, v42
    v_fmac_f32 v19, v27, v43
    v_fmac_f32 v20, v27, v44
    v_fmac_f32 v21, v27, v45
    v_fmac_f32 v22, v27, v46
    v_fmac_f32 v23, v27, v47
    v_lshlrev_b32 v32, 16, v176
    v_and_b32 v33, s46, v176
    v_lshlrev_b32 v34, 16, v177
    v_and_b32 v35, s46, v177
    v_lshlrev_b32 v36, 16, v178
    v_and_b32 v37, s46, v178
    v_lshlrev_b32 v38, 16, v179
    v_and_b32 v39, s46, v179
    v_fmac_f32 v16, v28, v32
    v_fmac_f32 v17, v28, v33
    v_fmac_f32 v18, v28, v34
    v_fmac_f32 v19, v28, v35
    v_fmac_f32 v20, v28, v36
    v_fmac_f32 v21, v28, v37
    v_fmac_f32 v22, v28, v38
    v_fmac_f32 v23, v28, v39
    v_lshlrev_b32 v40, 16, v180
    v_and_b32 v41, s46, v180
    v_lshlrev_b32 v42, 16, v181
    v_and_b32 v43, s46, v181
    v_lshlrev_b32 v44, 16, v182
    v_and_b32 v45, s46, v182
    v_lshlrev_b32 v46, 16, v183
    v_and_b32 v47, s46, v183
    v_fmac_f32 v16, v29, v40
    v_fmac_f32 v17, v29, v41
    v_fmac_f32 v18, v29, v42
    v_fmac_f32 v19, v29, v43
    v_fmac_f32 v20, v29, v44
    v_fmac_f32 v21, v29, v45
    v_fmac_f32 v22, v29, v46
    v_fmac_f32 v23, v29, v47
    v_lshlrev_b32 v32, 16, v184
    v_and_b32 v33, s46, v184
    v_lshlrev_b32 v34, 16, v185
    v_and_b32 v35, s46, v185
    v_lshlrev_b32 v36, 16, v186
    v_and_b32 v37, s46, v186
    v_lshlrev_b32 v38, 16, v187
    v_and_b32 v39, s46, v187
    v_fmac_f32 v16, v30, v32
    v_fmac_f32 v17, v30, v33
    v_fmac_f32 v18, v30, v34
    v_fmac_f32 v19, v30, v35
    v_fmac_f32 v20, v30, v36
    v_fmac_f32 v21, v30, v37
    v_fmac_f32 v22, v30, v38
    v_fmac_f32 v23, v30, v39
    v_lshlrev_b32 v40, 16, v188
    v_and_b32 v41, s46, v188
    v_lshlrev_b32 v42, 16, v189
    v_and_b32 v43, s46, v189
    v_lshlrev_b32 v44, 16, v190
    v_and_b32 v45, s46, v190
    v_lshlrev_b32 v46, 16, v191
    v_and_b32 v47, s46, v191
    v_fmac_f32 v16, v31, v40
    v_fmac_f32 v17, v31, v41
    v_fmac_f32 v18, v31, v42
    v_fmac_f32 v19, v31, v43
    v_fmac_f32 v20, v31, v44
    v_fmac_f32 v21, v31, v45
    v_fmac_f32 v22, v31, v46
    v_fmac_f32 v23, v31, v47
    global_load_dwordx4 v[160:163], v4, s[38:39] offset:0 nt
    global_load_dwordx4 v[164:167], v4, s[38:39] offset:256 nt
    global_load_dwordx4 v[168:171], v4, s[38:39] offset:512 nt
    global_load_dwordx4 v[172:175], v4, s[38:39] offset:768 nt
    global_load_dwordx4 v[176:179], v4, s[38:39] offset:1024 nt
    global_load_dwordx4 v[180:183], v4, s[38:39] offset:1280 nt
    global_load_dwordx4 v[184:187], v4, s[38:39] offset:1536 nt
    global_load_dwordx4 v[188:191], v4, s[38:39] offset:1792 nt
    v_add_u32 v4, 65536, v4
    s_lshl_b32 s33, s32, 11
    s_lshl_b32 s34, s54, 8
    s_add_u32 s34, s34, s33
    v_lshrrev_b32 v5, 2, v1
    v_lshlrev_b32 v5, 2, v5
    v_add_u32 v5, s34, v5
    ds_read_b32 v24, v5 offset:0
    ds_read_b32 v25, v5 offset:64
    ds_read_b32 v26, v5 offset:128
    ds_read_b32 v27, v5 offset:192
    s_waitcnt lgkmcnt(0)
    s_waitcnt vmcnt(32)
    v_lshlrev_b32 v32, 16, v192
    v_and_b32 v33, s46, v192
    v_lshlrev_b32 v34, 16, v193
    v_and_b32 v35, s46, v193
    v_lshlrev_b32 v36, 16, v194
    v_and_b32 v37, s46, v194
    v_lshlrev_b32 v38, 16, v195
    v_and_b32 v39, s46, v195
    v_mul_f32 v48, v24, v32
    v_mul_f32 v49, v24, v33
    v_mul_f32 v50, v24, v34
    v_mul_f32 v51, v24, v35
    v_mul_f32 v52, v24, v36
    v_mul_f32 v53, v24, v37
    v_mul_f32 v54, v24, v38
    v_mul_f32 v55, v24, v39
    v_lshlrev_b32 v32, 16, v196
    v_and_b32 v33, s46, v196
    v_lshlrev_b32 v34, 16, v197
    v_and_b32 v35, s46, v197
    v_lshlrev_b32 v36, 16, v198
    v_and_b32 v37, s46, v198
    v_lshlrev_b32 v38, 16, v199
    v_and_b32 v39, s46, v199
    v_fmac_f32 v48, v25, v32
    v_fmac_f32 v49, v25, v33
    v_fmac_f32 v50, v25, v34
    v_fmac_f32 v51, v25, v35
    v_fmac_f32 v52, v25, v36
    v_fmac_f32 v53, v25, v37
    v_fmac_f32 v54, v25, v38
    v_fmac_f32 v55, v25, v39
    v_lshlrev_b32 v32, 16, v200
    v_and_b32 v33, s46, v200
    v_lshlrev_b32 v34, 16, v201
    v_and_b32 v35, s46, v201
    v_lshlrev_b32 v36, 16, v202
    v_and_b32 v37, s46, v202
    v_lshlrev_b32 v38, 16, v203
    v_and_b32 v39, s46, v203
    v_fmac_f32 v48, v26, v32
    v_fmac_f32 v49, v26, v33
    v_fmac_f32 v50, v26, v34
    v_fmac_f32 v51, v26, v35
    v_fmac_f32 v52, v26, v36
    v_fmac_f32 v53, v26, v37
    v_fmac_f32 v54, v26, v38
    v_fmac_f32 v55, v26, v39
    v_lshlrev_b32 v32, 16, v204
    v_and_b32 v33, s46, v204
    v_lshlrev_b32 v34, 16, v205
    v_and_b32 v35, s46, v205
    v_lshlrev_b32 v36, 16, v206
    v_and_b32 v37, s46, v206
    v_lshlrev_b32 v38, 16, v207
    v_and_b32 v39, s46, v207
    v_fmac_f32 v48, v27, v32
    v_fmac_f32 v49, v27, v33
    v_fmac_f32 v50, v27, v34
    v_fmac_f32 v51, v27, v35
    v_fmac_f32 v52, v27, v36
    v_fmac_f32 v53, v27, v37
    v_fmac_f32 v54, v27, v38
    v_fmac_f32 v55, v27, v39
    v_lshlrev_b32 v32, 16, v208
    v_and_b32 v33, s46, v208
    v_lshlrev_b32 v34, 16, v209
    v_and_b32 v35, s46, v209
    v_lshlrev_b32 v36, 16, v210
    v_and_b32 v37, s46, v210
    v_lshlrev_b32 v38, 16, v211
    v_and_b32 v39, s46, v211
    v_mul_f32 v56, v24, v32
    v_mul_f32 v57, v24, v33
    v_mul_f32 v58, v24, v34
    v_mul_f32 v59, v24, v35
    v_mul_f32 v60, v24, v36
    v_mul_f32 v61, v24, v37
    v_mul_f32 v62, v24, v38
    v_mul_f32 v63, v24, v39
    v_lshlrev_b32 v32, 16, v212
    v_and_b32 v33, s46, v212
    v_lshlrev_b32 v34, 16, v213
    v_and_b32 v35, s46, v213
    v_lshlrev_b32 v36, 16, v214
    v_and_b32 v37, s46, v214
    v_lshlrev_b32 v38, 16, v215
    v_and_b32 v39, s46, v215
    v_fmac_f32 v56, v25, v32
    v_fmac_f32 v57, v25, v33
    v_fmac_f32 v58, v25, v34
    v_fmac_f32 v59, v25, v35
    v_fmac_f32 v60, v25, v36
    v_fmac_f32 v61, v25, v37
    v_fmac_f32 v62, v25, v38
    v_fmac_f32 v63, v25, v39
    v_lshlrev_b32 v32, 16, v216
    v_and_b32 v33, s46, v216
    v_lshlrev_b32 v34, 16, v217
    v_and_b32 v35, s46, v217
    v_lshlrev_b32 v36, 16, v218
    v_and_b32 v37, s46, v218
    v_lshlrev_b32 v38, 16, v219
    v_and_b32 v39, s46, v219
    v_fmac_f32 v56, v26, v32
    v_fmac_f32 v57, v26, v33
    v_fmac_f32 v58, v26, v34
    v_fmac_f32 v59, v26, v35
    v_fmac_f32 v60, v26, v36
    v_fmac_f32 v61, v26, v37
    v_fmac_f32 v62, v26, v38
    v_fmac_f32 v63, v26, v39
    v_lshlrev_b32 v32, 16, v220
    v_and_b32 v33, s46, v220
    v_lshlrev_b32 v34, 16, v221
    v_and_b32 v35, s46, v221
    v_lshlrev_b32 v36, 16, v222
    v_and_b32 v37, s46, v222
    v_lshlrev_b32 v38, 16, v223
    v_and_b32 v39, s46, v223
    v_fmac_f32 v56, v27, v32
    v_fmac_f32 v57, v27, v33
    v_fmac_f32 v58, v27, v34
    v_fmac_f32 v59, v27, v35
    v_fmac_f32 v60, v27, v36
    v_fmac_f32 v61, v27, v37
    v_fmac_f32 v62, v27, v38
    v_fmac_f32 v63, v27, v39
    v_add_f32_dpp v48, v48, v48 row_ror:4 row_mask:0xf bank_mask:0xf
    v_add_f32_dpp v49, v49, v49 row_ror:4 row_mask:0xf bank_mask:0xf
    v_add_f32_dpp v50, v50, v50 row_ror:4 row_mask:0xf bank_mask:0xf
    v_add_f32_dpp v51, v51, v51 row_ror:4 row_mask:0xf bank_mask:0xf
    v_add_f32_dpp v52, v52, v52 row_ror:4 row_mask:0xf bank_mask:0xf
    v_add_f32_dpp v53, v53, v53 row_ror:4 row_mask:0xf bank_mask:0xf
    v_add_f32_dpp v54, v54, v54 row_ror:4 row_mask:0xf bank_mask:0xf
    v_add_f32_dpp v55, v55, v55 row_ror:4 row_mask:0xf bank_mask:0xf
    v_add_f32_dpp v56, v56, v56 row_ror:4 row_mask:0xf bank_mask:0xf
    v_add_f32_dpp v57, v57, v57 row_ror:4 row_mask:0xf bank_mask:0xf
    v_add_f32_dpp v58, v58, v58 row_ror:4 row_mask:0xf bank_mask:0xf
    v_add_f32_dpp v59, v59, v59 row_ror:4 row_mask:0xf bank_mask:0xf
    v_add_f32_dpp v60, v60, v60 row_ror:4 row_mask:0xf bank_mask:0xf
    v_add_f32_dpp v61, v61, v61 row_ror:4 row_mask:0xf bank_mask:0xf
    v_add_f32_dpp v62, v62, v62 row_ror:4 row_mask:0xf bank_mask:0xf
    v_add_f32_dpp v63, v63, v63 row_ror:4 row_mask:0xf bank_mask:0xf
    v_add_f32_dpp v48, v48, v48 row_ror:8 row_mask:0xf bank_mask:0xf
    v_add_f32_dpp v49, v49, v49 row_ror:8 row_mask:0xf bank_mask:0xf
    v_add_f32_dpp v50, v50, v50 row_ror:8 row_mask:0xf bank_mask:0xf
    v_add_f32_dpp v51, v51, v51 row_ror:8 row_mask:0xf bank_mask:0xf
    v_add_f32_dpp v52, v52, v52 row_ror:8 row_mask:0xf bank_mask:0xf
    v_add_f32_dpp v53, v53, v53 row_ror:8 row_mask:0xf bank_mask:0xf
    v_add_f32_dpp v54, v54, v54 row_ror:8 row_mask:0xf bank_mask:0xf
    v_add_f32_dpp v55, v55, v55 row_ror:8 row_mask:0xf bank_mask:0xf
    v_add_f32_dpp v56, v56, v56 row_ror:8 row_mask:0xf bank_mask:0xf
    v_add_f32_dpp v57, v57, v57 row_ror:8 row_mask:0xf bank_mask:0xf
    v_add_f32_dpp v58, v58, v58 row_ror:8 row_mask:0xf bank_mask:0xf
    v_add_f32_dpp v59, v59, v59 row_ror:8 row_mask:0xf bank_mask:0xf
    v_add_f32_dpp v60, v60, v60 row_ror:8 row_mask:0xf bank_mask:0xf
    v_add_f32_dpp v61, v61, v61 row_ror:8 row_mask:0xf bank_mask:0xf
    v_add_f32_dpp v62, v62, v62 row_ror:8 row_mask:0xf bank_mask:0xf
    v_add_f32_dpp v63, v63, v63 row_ror:8 row_mask:0xf bank_mask:0xf
    s_lshl_b32 s33, s32, 10
    v_lshlrev_b32 v5, 8, v3
    v_lshl_add_u32 v5, v2, 5, v5
    v_add_u32 v5, s33, v5
    v_cmp_gt_u32 vcc, 4, v2
    s_nop 0
    s_and_saveexec_b64 s[52:53], vcc
    ds_write_b128 v5, v[48:51] offset:36864
    ds_write_b128 v5, v[52:55] offset:36880
    ds_write_b128 v5, v[56:59] offset:36992
    ds_write_b128 v5, v[60:63] offset:37008
    s_mov_b64 exec, s[52:53]
    v_lshlrev_b32 v5, 2, v1
    s_waitcnt lgkmcnt(0)
    s_barrier
    ds_read_b32 v48, v5 offset:36864
    ds_read_b32 v49, v5 offset:37120
    ds_read_b32 v50, v5 offset:37376
    ds_read_b32 v51, v5 offset:37632
    ds_read_b32 v52, v5 offset:37888
    ds_read_b32 v53, v5 offset:38144
    ds_read_b32 v54, v5 offset:38400
    ds_read_b32 v55, v5 offset:38656
    ds_read_b32 v56, v5 offset:38912
    ds_read_b32 v57, v5 offset:39168
    ds_read_b32 v58, v5 offset:39424
    ds_read_b32 v59, v5 offset:39680
    ds_read_b32 v60, v5 offset:39936
    ds_read_b32 v61, v5 offset:40192
    ds_read_b32 v62, v5 offset:40448
    ds_read_b32 v63, v5 offset:40704
    s_waitcnt lgkmcnt(0)
    v_add_f32 v48, v48, v49
    v_add_f32 v50, v50, v51
    v_add_f32 v52, v52, v53
    v_add_f32 v54, v54, v55
    v_add_f32 v56, v56, v57
    v_add_f32 v58, v58, v59
    v_add_f32 v60, v60, v61
    v_add_f32 v62, v62, v63
    v_add_f32 v48, v48, v50
    v_add_f32 v52, v52, v54
    v_add_f32 v56, v56, v58
    v_add_f32 v60, v60, v62
    v_add_f32 v48, v48, v52
    v_add_f32 v56, v56, v60
    v_add_f32 v32, v48, v56
    ds_read_b32 v48, v5 offset:40960
    ds_read_b32 v49, v5 offset:41216
    ds_read_b32 v50, v5 offset:41472
    ds_read_b32 v51, v5 offset:41728
    ds_read_b32 v52, v5 offset:41984
    ds_read_b32 v53, v5 offset:42240
    ds_read_b32 v54, v5 offset:42496
    ds_read_b32 v55, v5 offset:42752
    ds_read_b32 v56, v5 offset:43008
    ds_read_b32 v57, v5 offset:43264
    ds_read_b32 v58, v5 offset:43520
    ds_read_b32 v59, v5 offset:43776
    ds_read_b32 v60, v5 offset:44032
    ds_read_b32 v61, v5 offset:44288
    ds_read_b32 v62, v5 offset:44544
    ds_read_b32 v63, v5 offset:44800
    s_waitcnt lgkmcnt(0)
    v_add_f32 v48, v48, v49
    v_add_f32 v50, v50, v51
    v_add_f32 v52, v52, v53
    v_add_f32 v54, v54, v55
    v_add_f32 v56, v56, v57
    v_add_f32 v58, v58, v59
    v_add_f32 v60, v60, v61
    v_add_f32 v62, v62, v63
    v_add_f32 v48, v48, v50
    v_add_f32 v52, v52, v54
    v_add_f32 v56, v56, v58
    v_add_f32 v60, v60, v62
    v_add_f32 v48, v48, v52
    v_add_f32 v56, v56, v60
    v_add_f32 v48, v48, v56
    v_add_f32 v32, v32, v48
    v_cvt_pk_bf16_f32 v32, v32, v32
    v_lshlrev_b32 v32, 16, v32
    v_mov_b32 v33, v32
    s_nop 1
    v_permlane32_swap_b32 v32, v33
    v_mul_f32 v34, s45, v32
    v_max_f32 v34, 0xc2fc0000, v34
    v_exp_f32 v34, -v34
    s_nop 0
    v_add_f32 v34, 1.0, v34
    v_rcp_f32 v35, v34
    s_nop 0
    v_mul_f32 v36, v32, v35
    v_fma_f32 v37, -v36, v34, v32
    v_fmac_f32 v36, v37, v35
    v_cvt_pk_bf16_f32 v36, v36, v36
    v_lshlrev_b32 v36, 16, v36
    v_mul_f32 v36, v36, v33
    v_cvt_pk_bf16_f32 v36, v36, v36
    v_lshlrev_b32 v36, 16, v36
    s_lshl_b32 s33, s54, 2
    s_add_u32 s34, s33, 0
    v_readlane_b32 s48, v36, s34
    s_add_u32 s34, s33, 1
    v_readlane_b32 s49, v36, s34
    s_add_u32 s34, s33, 2
    v_readlane_b32 s50, v36, s34
    s_add_u32 s34, s33, 3
    v_readlane_b32 s51, v36, s34
    v_lshlrev_b32 v32, 16, v224
    v_and_b32 v33, s46, v224
    v_lshlrev_b32 v34, 16, v225
    v_and_b32 v35, s46, v225
    v_lshlrev_b32 v36, 16, v226
    v_and_b32 v37, s46, v226
    v_lshlrev_b32 v38, 16, v227
    v_and_b32 v39, s46, v227
    v_mul_f32 v48, s48, v32
    v_mul_f32 v49, s48, v33
    v_mul_f32 v50, s48, v34
    v_mul_f32 v51, s48, v35
    v_mul_f32 v52, s48, v36
    v_mul_f32 v53, s48, v37
    v_mul_f32 v54, s48, v38
    v_mul_f32 v55, s48, v39
    v_lshlrev_b32 v32, 16, v228
    v_and_b32 v33, s46, v228
    v_lshlrev_b32 v34, 16, v229
    v_and_b32 v35, s46, v229
    v_lshlrev_b32 v36, 16, v230
    v_and_b32 v37, s46, v230
    v_lshlrev_b32 v38, 16, v231
    v_and_b32 v39, s46, v231
    v_fmac_f32 v48, s49, v32
    v_fmac_f32 v49, s49, v33
    v_fmac_f32 v50, s49, v34
    v_fmac_f32 v51, s49, v35
    v_fmac_f32 v52, s49, v36
    v_fmac_f32 v53, s49, v37
    v_fmac_f32 v54, s49, v38
    v_fmac_f32 v55, s49, v39
    v_lshlrev_b32 v32, 16, v232
    v_and_b32 v33, s46, v232
    v_lshlrev_b32 v34, 16, v233
    v_and_b32 v35, s46, v233
    v_lshlrev_b32 v36, 16, v234
    v_and_b32 v37, s46, v234
    v_lshlrev_b32 v38, 16, v235
    v_and_b32 v39, s46, v235
    v_fmac_f32 v48, s50, v32
    v_fmac_f32 v49, s50, v33
    v_fmac_f32 v50, s50, v34
    v_fmac_f32 v51, s50, v35
    v_fmac_f32 v52, s50, v36
    v_fmac_f32 v53, s50, v37
    v_fmac_f32 v54, s50, v38
    v_fmac_f32 v55, s50, v39
    v_lshlrev_b32 v32, 16, v236
    v_and_b32 v33, s46, v236
    v_lshlrev_b32 v34, 16, v237
    v_and_b32 v35, s46, v237
    v_lshlrev_b32 v36, 16, v238
    v_and_b32 v37, s46, v238
    v_lshlrev_b32 v38, 16, v239
    v_and_b32 v39, s46, v239
    v_fmac_f32 v48, s51, v32
    v_fmac_f32 v49, s51, v33
    v_fmac_f32 v50, s51, v34
    v_fmac_f32 v51, s51, v35
    v_fmac_f32 v52, s51, v36
    v_fmac_f32 v53, s51, v37
    v_fmac_f32 v54, s51, v38
    v_fmac_f32 v55, s51, v39
    v_lshlrev_b32 v5, 5, v0
    ds_write_b128 v5, v[48:51] offset:45056
    ds_write_b128 v5, v[52:55] offset:45072
    v_lshlrev_b32 v5, 2, v0
    s_waitcnt lgkmcnt(0)
    s_barrier
    ds_read_b32 v48, v5 offset:45056
    ds_read_b32 v49, v5 offset:47104
    ds_read_b32 v50, v5 offset:49152
    ds_read_b32 v51, v5 offset:51200
    ds_read_b32 v52, v5 offset:53248
    ds_read_b32 v53, v5 offset:55296
    ds_read_b32 v54, v5 offset:57344
    ds_read_b32 v55, v5 offset:59392
    s_lshl_b32 s33, s29, 6
    s_add_u32 s43, s33, s31
    s_lshl_b32 s33, s43, 11
    s_add_u32 s33, s33, 1048576
    s_add_u32 s34, s26, s33
    s_addc_u32 s35, s27, 0
    s_waitcnt lgkmcnt(0)
    v_add_f32 v48, v48, v49
    v_add_f32 v50, v50, v51
    v_add_f32 v52, v52, v53
    v_add_f32 v54, v54, v55
    v_add_f32 v48, v48, v50
    v_add_f32 v52, v52, v54
    v_add_f32 v48, v48, v52
    s_cmp_ge_u32 s31, 56
    s_cbranch_scc1 L_skip_z
    global_store_dword v5, v48, s[34:35]
L_skip_z:
    s_lshl_b32 s33, s28, 17
    s_add_u32 s40, s12, s33
    s_addc_u32 s41, s13, 0
    s_lshl_b32 s33, s54, 7
    v_lshrrev_b32 v7, 3, v1
    v_lshlrev_b32 v7, 10, v7
    v_and_b32 v5, 7, v1
    v_lshl_add_u32 v7, v5, 4, v7
    v_add_u32 v7, s33, v7
    global_load_dwordx4 v[192:195], v7, s[40:41]
    v_add_u32 v7, 0x2000, v7
    global_load_dwordx4 v[196:199], v7, s[40:41]
    v_add_u32 v7, 0x2000, v7
    global_load_dwordx4 v[200:203], v7, s[40:41]
    v_add_u32 v7, 0x2000, v7
    global_load_dwordx4 v[204:207], v7, s[40:41]
    v_add_u32 v7, 0x2000, v7
    global_load_dwordx4 v[208:211], v7, s[40:41]
    v_add_u32 v7, 0x2000, v7
    global_load_dwordx4 v[212:215], v7, s[40:41]
    v_add_u32 v7, 0x2000, v7
    global_load_dwordx4 v[216:219], v7, s[40:41]
    v_add_u32 v7, 0x2000, v7
    global_load_dwordx4 v[220:223], v7, s[40:41]
    v_add_u32 v7, 0x2000, v7
    global_load_dwordx4 v[224:227], v7, s[40:41]
    v_add_u32 v7, 0x2000, v7
    global_load_dwordx4 v[228:231], v7, s[40:41]
    v_add_u32 v7, 0x2000, v7
    global_load_dwordx4 v[232:235], v7, s[40:41]
    v_add_u32 v7, 0x2000, v7
    global_load_dwordx4 v[236:239], v7, s[40:41]
    v_add_u32 v7, 0x2000, v7
    global_load_dwordx4 v[240:243], v7, s[40:41]
    v_add_u32 v7, 0x2000, v7
    global_load_dwordx4 v[244:247], v7, s[40:41]
    v_add_u32 v7, 0x2000, v7
    global_load_dwordx4 v[248:251], v7, s[40:41]
    v_add_u32 v7, 0x2000, v7
    global_load_dwordx4 v[252:255], v7, s[40:41]
    s_waitcnt vmcnt(40)
    v_dot2_f32_bf16 v24, v64, v8, 0
    v_dot2_f32_bf16 v25, v68, v8, 0
    v_dot2_f32_bf16 v26, v72, v8, 0
    v_dot2_f32_bf16 v27, v76, v8, 0
    v_dot2_f32_bf16 v28, v80, v8, 0
    v_dot2_f32_bf16 v29, v84, v8, 0
    v_dot2_f32_bf16 v30, v88, v8, 0
    v_dot2_f32_bf16 v31, v92, v8, 0
    v_dot2_f32_bf16 v24, v65, v9, v24
    v_dot2_f32_bf16 v25, v69, v9, v25
    v_dot2_f32_bf16 v26, v73, v9, v26
    v_dot2_f32_bf16 v27, v77, v9, v27
    v_dot2_f32_bf16 v28, v81, v9, v28
    v_dot2_f32_bf16 v29, v85, v9, v29
    v_dot2_f32_bf16 v30, v89, v9, v30
    v_dot2_f32_bf16 v31, v93, v9, v31
    v_dot2_f32_bf16 v24, v66, v10, v24
    v_dot2_f32_bf16 v25, v70, v10, v25
    v_dot2_f32_bf16 v26, v74, v10, v26
    v_dot2_f32_bf16 v27, v78, v10, v27
    v_dot2_f32_bf16 v28, v82, v10, v28
    v_dot2_f32_bf16 v29, v86, v10, v29
    v_dot2_f32_bf16 v30, v90, v10, v30
    v_dot2_f32_bf16 v31, v94, v10, v31
    v_dot2_f32_bf16 v24, v67, v11, v24
    v_dot2_f32_bf16 v25, v71, v11, v25
    v_dot2_f32_bf16 v26, v75, v11, v26
    v_dot2_f32_bf16 v27, v79, v11, v27
    v_dot2_f32_bf16 v28, v83, v11, v28
    v_dot2_f32_bf16 v29, v87, v11, v29
    v_dot2_f32_bf16 v30, v91, v11, v30
    v_dot2_f32_bf16 v31, v95, v11, v31
    global_load_dwordx4 v[64:67], v4, s[36:37] offset:0 nt
    global_load_dwordx4 v[68:71], v4, s[36:37] offset:256 nt
    global_load_dwordx4 v[72:75], v4, s[36:37] offset:512 nt
    global_load_dwordx4 v[76:79], v4, s[36:37] offset:768 nt
    global_load_dwordx4 v[80:83], v4, s[36:37] offset:1024 nt
    global_load_dwordx4 v[84:87], v4, s[36:37] offset:1280 nt
    global_load_dwordx4 v[88:91], v4, s[36:37] offset:1536 nt
    global_load_dwordx4 v[92:95], v4, s[36:37] offset:1792 nt
    v_add_f32_dpp v24, v24, v24 row_ror:8 row_mask:0xf bank_mask:0xf
    v_add_f32_dpp v25, v25, v25 row_ror:8 row_mask:0xf bank_mask:0xf
    v_add_f32_dpp v26, v26, v26 row_ror:8 row_mask:0xf bank_mask:0xf
    v_add_f32_dpp v27, v27, v27 row_ror:8 row_mask:0xf bank_mask:0xf
    v_add_f32_dpp v28, v28, v28 row_ror:8 row_mask:0xf bank_mask:0xf
    v_add_f32_dpp v29, v29, v29 row_ror:8 row_mask:0xf bank_mask:0xf
    v_add_f32_dpp v30, v30, v30 row_ror:8 row_mask:0xf bank_mask:0xf
    v_add_f32_dpp v31, v31, v31 row_ror:8 row_mask:0xf bank_mask:0xf
    v_add_f32_dpp v24, v24, v24 row_ror:4 row_mask:0xf bank_mask:0xf
    v_add_f32_dpp v25, v25, v25 row_ror:4 row_mask:0xf bank_mask:0xf
    v_add_f32_dpp v26, v26, v26 row_ror:4 row_mask:0xf bank_mask:0xf
    v_add_f32_dpp v27, v27, v27 row_ror:4 row_mask:0xf bank_mask:0xf
    v_add_f32_dpp v28, v28, v28 row_ror:4 row_mask:0xf bank_mask:0xf
    v_add_f32_dpp v29, v29, v29 row_ror:4 row_mask:0xf bank_mask:0xf
    v_add_f32_dpp v30, v30, v30 row_ror:4 row_mask:0xf bank_mask:0xf
    v_add_f32_dpp v31, v31, v31 row_ror:4 row_mask:0xf bank_mask:0xf
    v_add_f32_dpp v24, v24, v24 row_ror:2 row_mask:0xf bank_mask:0xf
    v_add_f32_dpp v25, v25, v25 row_ror:2 row_mask:0xf bank_mask:0xf
    v_add_f32_dpp v26, v26, v26 row_ror:2 row_mask:0xf bank_mask:0xf
    v_add_f32_dpp v27, v27, v27 row_ror:2 row_mask:0xf bank_mask:0xf
    v_add_f32_dpp v28, v28, v28 row_ror:2 row_mask:0xf bank_mask:0xf
    v_add_f32_dpp v29, v29, v29 row_ror:2 row_mask:0xf bank_mask:0xf
    v_add_f32_dpp v30, v30, v30 row_ror:2 row_mask:0xf bank_mask:0xf
    v_add_f32_dpp v31, v31, v31 row_ror:2 row_mask:0xf bank_mask:0xf
    v_add_f32_dpp v24, v24, v24 row_ror:1 row_mask:0xf bank_mask:0xf
    v_add_f32_dpp v25, v25, v25 row_ror:1 row_mask:0xf bank_mask:0xf
    v_add_f32_dpp v26, v26, v26 row_ror:1 row_mask:0xf bank_mask:0xf
    v_add_f32_dpp v27, v27, v27 row_ror:1 row_mask:0xf bank_mask:0xf
    v_add_f32_dpp v28, v28, v28 row_ror:1 row_mask:0xf bank_mask:0xf
    v_add_f32_dpp v29, v29, v29 row_ror:1 row_mask:0xf bank_mask:0xf
    v_add_f32_dpp v30, v30, v30 row_ror:1 row_mask:0xf bank_mask:0xf
    v_add_f32_dpp v31, v31, v31 row_ror:1 row_mask:0xf bank_mask:0xf
    v_cvt_pk_bf16_f32 v32, v24, v25
    v_cvt_pk_bf16_f32 v33, v26, v27
    v_cvt_pk_bf16_f32 v34, v28, v29
    v_cvt_pk_bf16_f32 v35, v30, v31
    v_lshlrev_b32 v24, 16, v32
    v_and_b32 v25, s46, v32
    v_lshlrev_b32 v26, 16, v33
    v_and_b32 v27, s46, v33
    v_lshlrev_b32 v28, 16, v34
    v_and_b32 v29, s46, v34
    v_lshlrev_b32 v30, 16, v35
    v_and_b32 v31, s46, v35
    v_mul_f32 v24, s44, v24
    v_mul_f32 v25, s44, v25
    v_mul_f32 v26, s44, v26
    v_mul_f32 v27, s44, v27
    v_mul_f32 v28, s44, v28
    v_mul_f32 v29, s44, v29
    v_mul_f32 v30, s44, v30
    v_mul_f32 v31, s44, v31
    v_cvt_pk_bf16_f32 v32, v24, v25
    v_cvt_pk_bf16_f32 v33, v26, v27
    v_cvt_pk_bf16_f32 v34, v28, v29
    v_cvt_pk_bf16_f32 v35, v30, v31
    v_lshlrev_b32 v24, 16, v32
    v_and_b32 v25, s46, v32
    v_lshlrev_b32 v26, 16, v33
    v_and_b32 v27, s46, v33
    v_lshlrev_b32 v28, 16, v34
    v_and_b32 v29, s46, v34
    v_lshlrev_b32 v30, 16, v35
    v_and_b32 v31, s46, v35
    v_max3_f32 v32, v24, v25, v26
    v_max3_f32 v33, v27, v28, v29
    v_max3_f32 v34, v30, v31, v12
    v_max3_f32 v12, v32, v33, v34
    v_mul_f32 v15, s45, v12
    v_sub_f32 v35, v14, v15
    v_exp_f32 v35, v35
    v_mov_b32 v14, v15
    v_fma_f32 v24, v24, s45, -v15
    v_fma_f32 v25, v25, s45, -v15
    v_fma_f32 v26, v26, s45, -v15
    v_fma_f32 v27, v27, s45, -v15
    v_fma_f32 v28, v28, s45, -v15
    v_fma_f32 v29, v29, s45, -v15
    v_fma_f32 v30, v30, s45, -v15
    v_fma_f32 v31, v31, s45, -v15
    v_exp_f32 v24, v24
    v_exp_f32 v25, v25
    v_exp_f32 v26, v26
    v_exp_f32 v27, v27
    v_exp_f32 v28, v28
    v_exp_f32 v29, v29
    v_exp_f32 v30, v30
    v_exp_f32 v31, v31
    v_mul_f32 v13, v13, v35
    v_mul_f32 v16, v16, v35
    v_mul_f32 v17, v17, v35
    v_mul_f32 v18, v18, v35
    v_mul_f32 v19, v19, v35
    v_mul_f32 v20, v20, v35
    v_mul_f32 v21, v21, v35
    v_mul_f32 v22, v22, v35
    v_mul_f32 v23, v23, v35
    v_add_f32 v36, v24, v25
    v_add_f32 v37, v26, v27
    v_add_f32 v38, v28, v29
    v_add_f32 v39, v30, v31
    v_add_f32 v36, v36, v37
    v_add_f32 v38, v38, v39
    v_add_f32 v36, v36, v38
    v_add_f32 v13, v13, v36
    s_waitcnt vmcnt(40)
    v_lshlrev_b32 v32, 16, v96
    v_and_b32 v33, s46, v96
    v_lshlrev_b32 v34, 16, v97
    v_and_b32 v35, s46, v97
    v_lshlrev_b32 v36, 16, v98
    v_and_b32 v37, s46, v98
    v_lshlrev_b32 v38, 16, v99
    v_and_b32 v39, s46, v99
    v_fmac_f32 v16, v24, v32
    v_fmac_f32 v17, v24, v33
    v_fmac_f32 v18, v24, v34
    v_fmac_f32 v19, v24, v35
    v_fmac_f32 v20, v24, v36
    v_fmac_f32 v21, v24, v37
    v_fmac_f32 v22, v24, v38
    v_fmac_f32 v23, v24, v39
    v_lshlrev_b32 v40, 16, v100
    v_and_b32 v41, s46, v100
    v_lshlrev_b32 v42, 16, v101
    v_and_b32 v43, s46, v101
    v_lshlrev_b32 v44, 16, v102
    v_and_b32 v45, s46, v102
    v_lshlrev_b32 v46, 16, v103
    v_and_b32 v47, s46, v103
    v_fmac_f32 v16, v25, v40
    v_fmac_f32 v17, v25, v41
    v_fmac_f32 v18, v25, v42
    v_fmac_f32 v19, v25, v43
    v_fmac_f32 v20, v25, v44
    v_fmac_f32 v21, v25, v45
    v_fmac_f32 v22, v25, v46
    v_fmac_f32 v23, v25, v47
    v_lshlrev_b32 v32, 16, v104
    v_and_b32 v33, s46, v104
    v_lshlrev_b32 v34, 16, v105
    v_and_b32 v35, s46, v105
    v_lshlrev_b32 v36, 16, v106
    v_and_b32 v37, s46, v106
    v_lshlrev_b32 v38, 16, v107
    v_and_b32 v39, s46, v107
    v_fmac_f32 v16, v26, v32
    v_fmac_f32 v17, v26, v33
    v_fmac_f32 v18, v26, v34
    v_fmac_f32 v19, v26, v35
    v_fmac_f32 v20, v26, v36
    v_fmac_f32 v21, v26, v37
    v_fmac_f32 v22, v26, v38
    v_fmac_f32 v23, v26, v39
    v_lshlrev_b32 v40, 16, v108
    v_and_b32 v41, s46, v108
    v_lshlrev_b32 v42, 16, v109
    v_and_b32 v43, s46, v109
    v_lshlrev_b32 v44, 16, v110
    v_and_b32 v45, s46, v110
    v_lshlrev_b32 v46, 16, v111
    v_and_b32 v47, s46, v111
    v_fmac_f32 v16, v27, v40
    v_fmac_f32 v17, v27, v41
    v_fmac_f32 v18, v27, v42
    v_fmac_f32 v19, v27, v43
    v_fmac_f32 v20, v27, v44
    v_fmac_f32 v21, v27, v45
    v_fmac_f32 v22, v27, v46
    v_fmac_f32 v23, v27, v47
    v_lshlrev_b32 v32, 16, v112
    v_and_b32 v33, s46, v112
    v_lshlrev_b32 v34, 16, v113
    v_and_b32 v35, s46, v113
    v_lshlrev_b32 v36, 16, v114
    v_and_b32 v37, s46, v114
    v_lshlrev_b32 v38, 16, v115
    v_and_b32 v39, s46, v115
    v_fmac_f32 v16, v28, v32
    v_fmac_f32 v17, v28, v33
    v_fmac_f32 v18, v28, v34
    v_fmac_f32 v19, v28, v35
    v_fmac_f32 v20, v28, v36
    v_fmac_f32 v21, v28, v37
    v_fmac_f32 v22, v28, v38
    v_fmac_f32 v23, v28, v39
    v_lshlrev_b32 v40, 16, v116
    v_and_b32 v41, s46, v116
    v_lshlrev_b32 v42, 16, v117
    v_and_b32 v43, s46, v117
    v_lshlrev_b32 v44, 16, v118
    v_and_b32 v45, s46, v118
    v_lshlrev_b32 v46, 16, v119
    v_and_b32 v47, s46, v119
    v_fmac_f32 v16, v29, v40
    v_fmac_f32 v17, v29, v41
    v_fmac_f32 v18, v29, v42
    v_fmac_f32 v19, v29, v43
    v_fmac_f32 v20, v29, v44
    v_fmac_f32 v21, v29, v45
    v_fmac_f32 v22, v29, v46
    v_fmac_f32 v23, v29, v47
    v_lshlrev_b32 v32, 16, v120
    v_and_b32 v33, s46, v120
    v_lshlrev_b32 v34, 16, v121
    v_and_b32 v35, s46, v121
    v_lshlrev_b32 v36, 16, v122
    v_and_b32 v37, s46, v122
    v_lshlrev_b32 v38, 16, v123
    v_and_b32 v39, s46, v123
    v_fmac_f32 v16, v30, v32
    v_fmac_f32 v17, v30, v33
    v_fmac_f32 v18, v30, v34
    v_fmac_f32 v19, v30, v35
    v_fmac_f32 v20, v30, v36
    v_fmac_f32 v21, v30, v37
    v_fmac_f32 v22, v30, v38
    v_fmac_f32 v23, v30, v39
    v_lshlrev_b32 v40, 16, v124
    v_and_b32 v41, s46, v124
    v_lshlrev_b32 v42, 16, v125
    v_and_b32 v43, s46, v125
    v_lshlrev_b32 v44, 16, v126
    v_and_b32 v45, s46, v126
    v_lshlrev_b32 v46, 16, v127
    v_and_b32 v47, s46, v127
    v_fmac_f32 v16, v31, v40
    v_fmac_f32 v17, v31, v41
    v_fmac_f32 v18, v31, v42
    v_fmac_f32 v19, v31, v43
    v_fmac_f32 v20, v31, v44
    v_fmac_f32 v21, v31, v45
    v_fmac_f32 v22, v31, v46
    v_fmac_f32 v23, v31, v47
    global_load_dwordx4 v[96:99], v4, s[38:39] offset:0 nt
    global_load_dwordx4 v[100:103], v4, s[38:39] offset:256 nt
    global_load_dwordx4 v[104:107], v4, s[38:39] offset:512 nt
    global_load_dwordx4 v[108:111], v4, s[38:39] offset:768 nt
    global_load_dwordx4 v[112:115], v4, s[38:39] offset:1024 nt
    global_load_dwordx4 v[116:119], v4, s[38:39] offset:1280 nt
    global_load_dwordx4 v[120:123], v4, s[38:39] offset:1536 nt
    global_load_dwordx4 v[124:127], v4, s[38:39] offset:1792 nt
    v_add_u32 v4, 65536, v4
    s_waitcnt vmcnt(40)
    v_dot2_f32_bf16 v24, v128, v8, 0
    v_dot2_f32_bf16 v25, v132, v8, 0
    v_dot2_f32_bf16 v26, v136, v8, 0
    v_dot2_f32_bf16 v27, v140, v8, 0
    v_dot2_f32_bf16 v28, v144, v8, 0
    v_dot2_f32_bf16 v29, v148, v8, 0
    v_dot2_f32_bf16 v30, v152, v8, 0
    v_dot2_f32_bf16 v31, v156, v8, 0
    v_dot2_f32_bf16 v24, v129, v9, v24
    v_dot2_f32_bf16 v25, v133, v9, v25
    v_dot2_f32_bf16 v26, v137, v9, v26
    v_dot2_f32_bf16 v27, v141, v9, v27
    v_dot2_f32_bf16 v28, v145, v9, v28
    v_dot2_f32_bf16 v29, v149, v9, v29
    v_dot2_f32_bf16 v30, v153, v9, v30
    v_dot2_f32_bf16 v31, v157, v9, v31
    v_dot2_f32_bf16 v24, v130, v10, v24
    v_dot2_f32_bf16 v25, v134, v10, v25
    v_dot2_f32_bf16 v26, v138, v10, v26
    v_dot2_f32_bf16 v27, v142, v10, v27
    v_dot2_f32_bf16 v28, v146, v10, v28
    v_dot2_f32_bf16 v29, v150, v10, v29
    v_dot2_f32_bf16 v30, v154, v10, v30
    v_dot2_f32_bf16 v31, v158, v10, v31
    v_dot2_f32_bf16 v24, v131, v11, v24
    v_dot2_f32_bf16 v25, v135, v11, v25
    v_dot2_f32_bf16 v26, v139, v11, v26
    v_dot2_f32_bf16 v27, v143, v11, v27
    v_dot2_f32_bf16 v28, v147, v11, v28
    v_dot2_f32_bf16 v29, v151, v11, v29
    v_dot2_f32_bf16 v30, v155, v11, v30
    v_dot2_f32_bf16 v31, v159, v11, v31
    global_load_dwordx4 v[128:131], v4, s[36:37] offset:0 nt
    global_load_dwordx4 v[132:135], v4, s[36:37] offset:256 nt
    global_load_dwordx4 v[136:139], v4, s[36:37] offset:512 nt
    global_load_dwordx4 v[140:143], v4, s[36:37] offset:768 nt
    global_load_dwordx4 v[144:147], v4, s[36:37] offset:1024 nt
    global_load_dwordx4 v[148:151], v4, s[36:37] offset:1280 nt
    global_load_dwordx4 v[152:155], v4, s[36:37] offset:1536 nt
    global_load_dwordx4 v[156:159], v4, s[36:37] offset:1792 nt
    v_add_f32_dpp v24, v24, v24 row_ror:8 row_mask:0xf bank_mask:0xf
    v_add_f32_dpp v25, v25, v25 row_ror:8 row_mask:0xf bank_mask:0xf
    v_add_f32_dpp v26, v26, v26 row_ror:8 row_mask:0xf bank_mask:0xf
    v_add_f32_dpp v27, v27, v27 row_ror:8 row_mask:0xf bank_mask:0xf
    v_add_f32_dpp v28, v28, v28 row_ror:8 row_mask:0xf bank_mask:0xf
    v_add_f32_dpp v29, v29, v29 row_ror:8 row_mask:0xf bank_mask:0xf
    v_add_f32_dpp v30, v30, v30 row_ror:8 row_mask:0xf bank_mask:0xf
    v_add_f32_dpp v31, v31, v31 row_ror:8 row_mask:0xf bank_mask:0xf
    v_add_f32_dpp v24, v24, v24 row_ror:4 row_mask:0xf bank_mask:0xf
    v_add_f32_dpp v25, v25, v25 row_ror:4 row_mask:0xf bank_mask:0xf
    v_add_f32_dpp v26, v26, v26 row_ror:4 row_mask:0xf bank_mask:0xf
    v_add_f32_dpp v27, v27, v27 row_ror:4 row_mask:0xf bank_mask:0xf
    v_add_f32_dpp v28, v28, v28 row_ror:4 row_mask:0xf bank_mask:0xf
    v_add_f32_dpp v29, v29, v29 row_ror:4 row_mask:0xf bank_mask:0xf
    v_add_f32_dpp v30, v30, v30 row_ror:4 row_mask:0xf bank_mask:0xf
    v_add_f32_dpp v31, v31, v31 row_ror:4 row_mask:0xf bank_mask:0xf
    v_add_f32_dpp v24, v24, v24 row_ror:2 row_mask:0xf bank_mask:0xf
    v_add_f32_dpp v25, v25, v25 row_ror:2 row_mask:0xf bank_mask:0xf
    v_add_f32_dpp v26, v26, v26 row_ror:2 row_mask:0xf bank_mask:0xf
    v_add_f32_dpp v27, v27, v27 row_ror:2 row_mask:0xf bank_mask:0xf
    v_add_f32_dpp v28, v28, v28 row_ror:2 row_mask:0xf bank_mask:0xf
    v_add_f32_dpp v29, v29, v29 row_ror:2 row_mask:0xf bank_mask:0xf
    v_add_f32_dpp v30, v30, v30 row_ror:2 row_mask:0xf bank_mask:0xf
    v_add_f32_dpp v31, v31, v31 row_ror:2 row_mask:0xf bank_mask:0xf
    v_add_f32_dpp v24, v24, v24 row_ror:1 row_mask:0xf bank_mask:0xf
    v_add_f32_dpp v25, v25, v25 row_ror:1 row_mask:0xf bank_mask:0xf
    v_add_f32_dpp v26, v26, v26 row_ror:1 row_mask:0xf bank_mask:0xf
    v_add_f32_dpp v27, v27, v27 row_ror:1 row_mask:0xf bank_mask:0xf
    v_add_f32_dpp v28, v28, v28 row_ror:1 row_mask:0xf bank_mask:0xf
    v_add_f32_dpp v29, v29, v29 row_ror:1 row_mask:0xf bank_mask:0xf
    v_add_f32_dpp v30, v30, v30 row_ror:1 row_mask:0xf bank_mask:0xf
    v_add_f32_dpp v31, v31, v31 row_ror:1 row_mask:0xf bank_mask:0xf
    v_cvt_pk_bf16_f32 v32, v24, v25
    v_cvt_pk_bf16_f32 v33, v26, v27
    v_cvt_pk_bf16_f32 v34, v28, v29
    v_cvt_pk_bf16_f32 v35, v30, v31
    v_lshlrev_b32 v24, 16, v32
    v_and_b32 v25, s46, v32
    v_lshlrev_b32 v26, 16, v33
    v_and_b32 v27, s46, v33
    v_lshlrev_b32 v28, 16, v34
    v_and_b32 v29, s46, v34
    v_lshlrev_b32 v30, 16, v35
    v_and_b32 v31, s46, v35
    v_mul_f32 v24, s44, v24
    v_mul_f32 v25, s44, v25
    v_mul_f32 v26, s44, v26
    v_mul_f32 v27, s44, v27
    v_mul_f32 v28, s44, v28
    v_mul_f32 v29, s44, v29
    v_mul_f32 v30, s44, v30
    v_mul_f32 v31, s44, v31
    v_cvt_pk_bf16_f32 v32, v24, v25
    v_cvt_pk_bf16_f32 v33, v26, v27
    v_cvt_pk_bf16_f32 v34, v28, v29
    v_cvt_pk_bf16_f32 v35, v30, v31
    v_lshlrev_b32 v24, 16, v32
    v_and_b32 v25, s46, v32
    v_lshlrev_b32 v26, 16, v33
    v_and_b32 v27, s46, v33
    v_lshlrev_b32 v28, 16, v34
    v_and_b32 v29, s46, v34
    v_lshlrev_b32 v30, 16, v35
    v_and_b32 v31, s46, v35
    v_max3_f32 v32, v24, v25, v26
    v_max3_f32 v33, v27, v28, v29
    v_max3_f32 v34, v30, v31, v12
    v_max3_f32 v12, v32, v33, v34
    v_mul_f32 v15, s45, v12
    v_sub_f32 v35, v14, v15
    v_exp_f32 v35, v35
    v_mov_b32 v14, v15
    v_fma_f32 v24, v24, s45, -v15
    v_fma_f32 v25, v25, s45, -v15
    v_fma_f32 v26, v26, s45, -v15
    v_fma_f32 v27, v27, s45, -v15
    v_fma_f32 v28, v28, s45, -v15
    v_fma_f32 v29, v29, s45, -v15
    v_fma_f32 v30, v30, s45, -v15
    v_fma_f32 v31, v31, s45, -v15
    v_exp_f32 v24, v24
    v_exp_f32 v25, v25
    v_exp_f32 v26, v26
    v_exp_f32 v27, v27
    v_exp_f32 v28, v28
    v_exp_f32 v29, v29
    v_exp_f32 v30, v30
    v_exp_f32 v31, v31
    v_mul_f32 v13, v13, v35
    v_mul_f32 v16, v16, v35
    v_mul_f32 v17, v17, v35
    v_mul_f32 v18, v18, v35
    v_mul_f32 v19, v19, v35
    v_mul_f32 v20, v20, v35
    v_mul_f32 v21, v21, v35
    v_mul_f32 v22, v22, v35
    v_mul_f32 v23, v23, v35
    v_add_f32 v36, v24, v25
    v_add_f32 v37, v26, v27
    v_add_f32 v38, v28, v29
    v_add_f32 v39, v30, v31
    v_add_f32 v36, v36, v37
    v_add_f32 v38, v38, v39
    v_add_f32 v36, v36, v38
    v_add_f32 v13, v13, v36
    s_waitcnt vmcnt(40)
    v_lshlrev_b32 v32, 16, v160
    v_and_b32 v33, s46, v160
    v_lshlrev_b32 v34, 16, v161
    v_and_b32 v35, s46, v161
    v_lshlrev_b32 v36, 16, v162
    v_and_b32 v37, s46, v162
    v_lshlrev_b32 v38, 16, v163
    v_and_b32 v39, s46, v163
    v_fmac_f32 v16, v24, v32
    v_fmac_f32 v17, v24, v33
    v_fmac_f32 v18, v24, v34
    v_fmac_f32 v19, v24, v35
    v_fmac_f32 v20, v24, v36
    v_fmac_f32 v21, v24, v37
    v_fmac_f32 v22, v24, v38
    v_fmac_f32 v23, v24, v39
    v_lshlrev_b32 v40, 16, v164
    v_and_b32 v41, s46, v164
    v_lshlrev_b32 v42, 16, v165
    v_and_b32 v43, s46, v165
    v_lshlrev_b32 v44, 16, v166
    v_and_b32 v45, s46, v166
    v_lshlrev_b32 v46, 16, v167
    v_and_b32 v47, s46, v167
    v_fmac_f32 v16, v25, v40
    v_fmac_f32 v17, v25, v41
    v_fmac_f32 v18, v25, v42
    v_fmac_f32 v19, v25, v43
    v_fmac_f32 v20, v25, v44
    v_fmac_f32 v21, v25, v45
    v_fmac_f32 v22, v25, v46
    v_fmac_f32 v23, v25, v47
    v_lshlrev_b32 v32, 16, v168
    v_and_b32 v33, s46, v168
    v_lshlrev_b32 v34, 16, v169
    v_and_b32 v35, s46, v169
    v_lshlrev_b32 v36, 16, v170
    v_and_b32 v37, s46, v170
    v_lshlrev_b32 v38, 16, v171
    v_and_b32 v39, s46, v171
    v_fmac_f32 v16, v26, v32
    v_fmac_f32 v17, v26, v33
    v_fmac_f32 v18, v26, v34
    v_fmac_f32 v19, v26, v35
    v_fmac_f32 v20, v26, v36
    v_fmac_f32 v21, v26, v37
    v_fmac_f32 v22, v26, v38
    v_fmac_f32 v23, v26, v39
    v_lshlrev_b32 v40, 16, v172
    v_and_b32 v41, s46, v172
    v_lshlrev_b32 v42, 16, v173
    v_and_b32 v43, s46, v173
    v_lshlrev_b32 v44, 16, v174
    v_and_b32 v45, s46, v174
    v_lshlrev_b32 v46, 16, v175
    v_and_b32 v47, s46, v175
    v_fmac_f32 v16, v27, v40
    v_fmac_f32 v17, v27, v41
    v_fmac_f32 v18, v27, v42
    v_fmac_f32 v19, v27, v43
    v_fmac_f32 v20, v27, v44
    v_fmac_f32 v21, v27, v45
    v_fmac_f32 v22, v27, v46
    v_fmac_f32 v23, v27, v47
    v_lshlrev_b32 v32, 16, v176
    v_and_b32 v33, s46, v176
    v_lshlrev_b32 v34, 16, v177
    v_and_b32 v35, s46, v177
    v_lshlrev_b32 v36, 16, v178
    v_and_b32 v37, s46, v178
    v_lshlrev_b32 v38, 16, v179
    v_and_b32 v39, s46, v179
    v_fmac_f32 v16, v28, v32
    v_fmac_f32 v17, v28, v33
    v_fmac_f32 v18, v28, v34
    v_fmac_f32 v19, v28, v35
    v_fmac_f32 v20, v28, v36
    v_fmac_f32 v21, v28, v37
    v_fmac_f32 v22, v28, v38
    v_fmac_f32 v23, v28, v39
    v_lshlrev_b32 v40, 16, v180
    v_and_b32 v41, s46, v180
    v_lshlrev_b32 v42, 16, v181
    v_and_b32 v43, s46, v181
    v_lshlrev_b32 v44, 16, v182
    v_and_b32 v45, s46, v182
    v_lshlrev_b32 v46, 16, v183
    v_and_b32 v47, s46, v183
    v_fmac_f32 v16, v29, v40
    v_fmac_f32 v17, v29, v41
    v_fmac_f32 v18, v29, v42
    v_fmac_f32 v19, v29, v43
    v_fmac_f32 v20, v29, v44
    v_fmac_f32 v21, v29, v45
    v_fmac_f32 v22, v29, v46
    v_fmac_f32 v23, v29, v47
    v_lshlrev_b32 v32, 16, v184
    v_and_b32 v33, s46, v184
    v_lshlrev_b32 v34, 16, v185
    v_and_b32 v35, s46, v185
    v_lshlrev_b32 v36, 16, v186
    v_and_b32 v37, s46, v186
    v_lshlrev_b32 v38, 16, v187
    v_and_b32 v39, s46, v187
    v_fmac_f32 v16, v30, v32
    v_fmac_f32 v17, v30, v33
    v_fmac_f32 v18, v30, v34
    v_fmac_f32 v19, v30, v35
    v_fmac_f32 v20, v30, v36
    v_fmac_f32 v21, v30, v37
    v_fmac_f32 v22, v30, v38
    v_fmac_f32 v23, v30, v39
    v_lshlrev_b32 v40, 16, v188
    v_and_b32 v41, s46, v188
    v_lshlrev_b32 v42, 16, v189
    v_and_b32 v43, s46, v189
    v_lshlrev_b32 v44, 16, v190
    v_and_b32 v45, s46, v190
    v_lshlrev_b32 v46, 16, v191
    v_and_b32 v47, s46, v191
    v_fmac_f32 v16, v31, v40
    v_fmac_f32 v17, v31, v41
    v_fmac_f32 v18, v31, v42
    v_fmac_f32 v19, v31, v43
    v_fmac_f32 v20, v31, v44
    v_fmac_f32 v21, v31, v45
    v_fmac_f32 v22, v31, v46
    v_fmac_f32 v23, v31, v47
    global_load_dwordx4 v[160:163], v4, s[38:39] offset:0 nt
    global_load_dwordx4 v[164:167], v4, s[38:39] offset:256 nt
    global_load_dwordx4 v[168:171], v4, s[38:39] offset:512 nt
    global_load_dwordx4 v[172:175], v4, s[38:39] offset:768 nt
    global_load_dwordx4 v[176:179], v4, s[38:39] offset:1024 nt
    global_load_dwordx4 v[180:183], v4, s[38:39] offset:1280 nt
    global_load_dwordx4 v[184:187], v4, s[38:39] offset:1536 nt
    global_load_dwordx4 v[188:191], v4, s[38:39] offset:1792 nt
    v_add_u32 v4, 65536, v4
    s_waitcnt vmcnt(32)
    s_lshl_b32 s33, s32, 13
    s_add_u32 s33, s33, 65536
    v_add_u32 v7, s33, v6
    v_bfe_u32 v5, v1, 2, 2
    v_lshl_add_u32 v5, v3, 3, v5
    v_lshlrev_b32 v5, 7, v5
    v_and_b32 v32, 3, v1
    v_lshl_add_u32 v5, v32, 3, v5
    v_add_u32 v5, s33, v5
    ds_write_b128 v7, v[192:195] offset:0
    ds_write_b128 v7, v[196:199] offset:1024
    ds_write_b128 v7, v[200:203] offset:2048
    ds_write_b128 v7, v[204:207] offset:3072
    ds_write_b128 v7, v[208:211] offset:4096
    ds_write_b128 v7, v[212:215] offset:5120
    ds_write_b128 v7, v[216:219] offset:6144
    ds_write_b128 v7, v[220:223] offset:7168
    s_waitcnt lgkmcnt(0)
    ds_read_b64_tr_b16 v[192:193], v5 offset:0
    ds_read_b64_tr_b16 v[194:195], v5 offset:512
    ds_read_b64_tr_b16 v[196:197], v5 offset:32
    ds_read_b64_tr_b16 v[198:199], v5 offset:544
    ds_read_b64_tr_b16 v[200:201], v5 offset:64
    ds_read_b64_tr_b16 v[202:203], v5 offset:576
    ds_read_b64_tr_b16 v[204:205], v5 offset:96
    ds_read_b64_tr_b16 v[206:207], v5 offset:608
    ds_read_b64_tr_b16 v[208:209], v5 offset:4096
    ds_read_b64_tr_b16 v[210:211], v5 offset:4608
    ds_read_b64_tr_b16 v[212:213], v5 offset:4128
    ds_read_b64_tr_b16 v[214:215], v5 offset:4640
    ds_read_b64_tr_b16 v[216:217], v5 offset:4160
    ds_read_b64_tr_b16 v[218:219], v5 offset:4672
    ds_read_b64_tr_b16 v[220:221], v5 offset:4192
    ds_read_b64_tr_b16 v[222:223], v5 offset:4704
    s_waitcnt lgkmcnt(0)
    ds_write_b128 v7, v[224:227] offset:0
    ds_write_b128 v7, v[228:231] offset:1024
    ds_write_b128 v7, v[232:235] offset:2048
    ds_write_b128 v7, v[236:239] offset:3072
    ds_write_b128 v7, v[240:243] offset:4096
    ds_write_b128 v7, v[244:247] offset:5120
    ds_write_b128 v7, v[248:251] offset:6144
    ds_write_b128 v7, v[252:255] offset:7168
    s_waitcnt lgkmcnt(0)
    ds_read_b64_tr_b16 v[224:225], v5 offset:0
    ds_read_b64_tr_b16 v[226:227], v5 offset:512
    ds_read_b64_tr_b16 v[228:229], v5 offset:32
    ds_read_b64_tr_b16 v[230:231], v5 offset:544
    ds_read_b64_tr_b16 v[232:233], v5 offset:64
    ds_read_b64_tr_b16 v[234:235], v5 offset:576
    ds_read_b64_tr_b16 v[236:237], v5 offset:96
    ds_read_b64_tr_b16 v[238:239], v5 offset:608
    ds_read_b64_tr_b16 v[240:241], v5 offset:4096
    ds_read_b64_tr_b16 v[242:243], v5 offset:4608
    ds_read_b64_tr_b16 v[244:245], v5 offset:4128
    ds_read_b64_tr_b16 v[246:247], v5 offset:4640
    ds_read_b64_tr_b16 v[248:249], v5 offset:4160
    ds_read_b64_tr_b16 v[250:251], v5 offset:4672
    ds_read_b64_tr_b16 v[252:253], v5 offset:4192
    ds_read_b64_tr_b16 v[254:255], v5 offset:4704
    s_waitcnt lgkmcnt(0)
    s_mov_b32 s47, 0
.p2align 6
L_loop:
    s_waitcnt vmcnt(24)
    v_dot2_f32_bf16 v24, v64, v8, 0
    v_dot2_f32_bf16 v25, v68, v8, 0
    v_dot2_f32_bf16 v26, v72, v8, 0
    v_dot2_f32_bf16 v27, v76, v8, 0
    v_dot2_f32_bf16 v28, v80, v8, 0
    v_dot2_f32_bf16 v29, v84, v8, 0
    v_dot2_f32_bf16 v30, v88, v8, 0
    v_dot2_f32_bf16 v31, v92, v8, 0
    v_dot2_f32_bf16 v24, v65, v9, v24
    v_dot2_f32_bf16 v25, v69, v9, v25
    v_dot2_f32_bf16 v26, v73, v9, v26
    v_dot2_f32_bf16 v27, v77, v9, v27
    v_dot2_f32_bf16 v28, v81, v9, v28
    v_dot2_f32_bf16 v29, v85, v9, v29
    v_dot2_f32_bf16 v30, v89, v9, v30
    v_dot2_f32_bf16 v31, v93, v9, v31
    v_dot2_f32_bf16 v24, v66, v10, v24
    v_dot2_f32_bf16 v25, v70, v10, v25
    v_dot2_f32_bf16 v26, v74, v10, v26
    v_dot2_f32_bf16 v27, v78, v10, v27
    v_dot2_f32_bf16 v28, v82, v10, v28
    v_dot2_f32_bf16 v29, v86, v10, v29
    v_dot2_f32_bf16 v30, v90, v10, v30
    v_dot2_f32_bf16 v31, v94, v10, v31
    v_dot2_f32_bf16 v24, v67, v11, v24
    v_dot2_f32_bf16 v25, v71, v11, v25
    v_dot2_f32_bf16 v26, v75, v11, v26
    v_dot2_f32_bf16 v27, v79, v11, v27
    v_dot2_f32_bf16 v28, v83, v11, v28
    v_dot2_f32_bf16 v29, v87, v11, v29
    v_dot2_f32_bf16 v30, v91, v11, v30
    v_dot2_f32_bf16 v31, v95, v11, v31
    global_load_dwordx4 v[64:67], v4, s[36:37] offset:0 nt
    global_load_dwordx4 v[68:71], v4, s[36:37] offset:256 nt
    global_load_dwordx4 v[72:75], v4, s[36:37] offset:512 nt
    global_load_dwordx4 v[76:79], v4, s[36:37] offset:768 nt
    global_load_dwordx4 v[80:83], v4, s[36:37] offset:1024 nt
    global_load_dwordx4 v[84:87], v4, s[36:37] offset:1280 nt
    global_load_dwordx4 v[88:91], v4, s[36:37] offset:1536 nt
    global_load_dwordx4 v[92:95], v4, s[36:37] offset:1792 nt
    v_add_f32_dpp v24, v24, v24 row_ror:8 row_mask:0xf bank_mask:0xf
    v_add_f32_dpp v25, v25, v25 row_ror:8 row_mask:0xf bank_mask:0xf
    v_add_f32_dpp v26, v26, v26 row_ror:8 row_mask:0xf bank_mask:0xf
    v_add_f32_dpp v27, v27, v27 row_ror:8 row_mask:0xf bank_mask:0xf
    v_add_f32_dpp v28, v28, v28 row_ror:8 row_mask:0xf bank_mask:0xf
    v_add_f32_dpp v29, v29, v29 row_ror:8 row_mask:0xf bank_mask:0xf
    v_add_f32_dpp v30, v30, v30 row_ror:8 row_mask:0xf bank_mask:0xf
    v_add_f32_dpp v31, v31, v31 row_ror:8 row_mask:0xf bank_mask:0xf
    v_add_f32_dpp v24, v24, v24 row_ror:4 row_mask:0xf bank_mask:0xf
    v_add_f32_dpp v25, v25, v25 row_ror:4 row_mask:0xf bank_mask:0xf
    v_add_f32_dpp v26, v26, v26 row_ror:4 row_mask:0xf bank_mask:0xf
    v_add_f32_dpp v27, v27, v27 row_ror:4 row_mask:0xf bank_mask:0xf
    v_add_f32_dpp v28, v28, v28 row_ror:4 row_mask:0xf bank_mask:0xf
    v_add_f32_dpp v29, v29, v29 row_ror:4 row_mask:0xf bank_mask:0xf
    v_add_f32_dpp v30, v30, v30 row_ror:4 row_mask:0xf bank_mask:0xf
    v_add_f32_dpp v31, v31, v31 row_ror:4 row_mask:0xf bank_mask:0xf
    v_add_f32_dpp v24, v24, v24 row_ror:2 row_mask:0xf bank_mask:0xf
    v_add_f32_dpp v25, v25, v25 row_ror:2 row_mask:0xf bank_mask:0xf
    v_add_f32_dpp v26, v26, v26 row_ror:2 row_mask:0xf bank_mask:0xf
    v_add_f32_dpp v27, v27, v27 row_ror:2 row_mask:0xf bank_mask:0xf
    v_add_f32_dpp v28, v28, v28 row_ror:2 row_mask:0xf bank_mask:0xf
    v_add_f32_dpp v29, v29, v29 row_ror:2 row_mask:0xf bank_mask:0xf
    v_add_f32_dpp v30, v30, v30 row_ror:2 row_mask:0xf bank_mask:0xf
    v_add_f32_dpp v31, v31, v31 row_ror:2 row_mask:0xf bank_mask:0xf
    v_add_f32_dpp v24, v24, v24 row_ror:1 row_mask:0xf bank_mask:0xf
    v_add_f32_dpp v25, v25, v25 row_ror:1 row_mask:0xf bank_mask:0xf
    v_add_f32_dpp v26, v26, v26 row_ror:1 row_mask:0xf bank_mask:0xf
    v_add_f32_dpp v27, v27, v27 row_ror:1 row_mask:0xf bank_mask:0xf
    v_add_f32_dpp v28, v28, v28 row_ror:1 row_mask:0xf bank_mask:0xf
    v_add_f32_dpp v29, v29, v29 row_ror:1 row_mask:0xf bank_mask:0xf
    v_add_f32_dpp v30, v30, v30 row_ror:1 row_mask:0xf bank_mask:0xf
    v_add_f32_dpp v31, v31, v31 row_ror:1 row_mask:0xf bank_mask:0xf
    v_cvt_pk_bf16_f32 v32, v24, v25
    v_cvt_pk_bf16_f32 v33, v26, v27
    v_cvt_pk_bf16_f32 v34, v28, v29
    v_cvt_pk_bf16_f32 v35, v30, v31
    v_lshlrev_b32 v24, 16, v32
    v_and_b32 v25, s46, v32
    v_lshlrev_b32 v26, 16, v33
    v_and_b32 v27, s46, v33
    v_lshlrev_b32 v28, 16, v34
    v_and_b32 v29, s46, v34
    v_lshlrev_b32 v30, 16, v35
    v_and_b32 v31, s46, v35
    v_mul_f32 v24, s44, v24
    v_mul_f32 v25, s44, v25
    v_mul_f32 v26, s44, v26
    v_mul_f32 v27, s44, v27
    v_mul_f32 v28, s44, v28
    v_mul_f32 v29, s44, v29
    v_mul_f32 v30, s44, v30
    v_mul_f32 v31, s44, v31
    v_cvt_pk_bf16_f32 v32, v24, v25
    v_cvt_pk_bf16_f32 v33, v26, v27
    v_cvt_pk_bf16_f32 v34, v28, v29
    v_cvt_pk_bf16_f32 v35, v30, v31
    v_lshlrev_b32 v24, 16, v32
    v_and_b32 v25, s46, v32
    v_lshlrev_b32 v26, 16, v33
    v_and_b32 v27, s46, v33
    v_lshlrev_b32 v28, 16, v34
    v_and_b32 v29, s46, v34
    v_lshlrev_b32 v30, 16, v35
    v_and_b32 v31, s46, v35
    v_max3_f32 v32, v24, v25, v26
    v_max3_f32 v33, v27, v28, v29
    v_max3_f32 v34, v30, v31, v12
    v_max3_f32 v12, v32, v33, v34
    v_mul_f32 v15, s45, v12
    v_sub_f32 v35, v14, v15
    v_exp_f32 v35, v35
    v_mov_b32 v14, v15
    v_fma_f32 v24, v24, s45, -v15
    v_fma_f32 v25, v25, s45, -v15
    v_fma_f32 v26, v26, s45, -v15
    v_fma_f32 v27, v27, s45, -v15
    v_fma_f32 v28, v28, s45, -v15
    v_fma_f32 v29, v29, s45, -v15
    v_fma_f32 v30, v30, s45, -v15
    v_fma_f32 v31, v31, s45, -v15
    v_exp_f32 v24, v24
    v_exp_f32 v25, v25
    v_exp_f32 v26, v26
    v_exp_f32 v27, v27
    v_exp_f32 v28, v28
    v_exp_f32 v29, v29
    v_exp_f32 v30, v30
    v_exp_f32 v31, v31
    v_mul_f32 v13, v13, v35
    v_mul_f32 v16, v16, v35
    v_mul_f32 v17, v17, v35
    v_mul_f32 v18, v18, v35
    v_mul_f32 v19, v19, v35
    v_mul_f32 v20, v20, v35
    v_mul_f32 v21, v21, v35
    v_mul_f32 v22, v22, v35
    v_mul_f32 v23, v23, v35
    v_add_f32 v36, v24, v25
    v_add_f32 v37, v26, v27
    v_add_f32 v38, v28, v29
    v_add_f32 v39, v30, v31
    v_add_f32 v36, v36, v37
    v_add_f32 v38, v38, v39
    v_add_f32 v36, v36, v38
    v_add_f32 v13, v13, v36
    s_waitcnt vmcnt(24)
    v_lshlrev_b32 v32, 16, v96
    v_and_b32 v33, s46, v96
    v_lshlrev_b32 v34, 16, v97
    v_and_b32 v35, s46, v97
    v_lshlrev_b32 v36, 16, v98
    v_and_b32 v37, s46, v98
    v_lshlrev_b32 v38, 16, v99
    v_and_b32 v39, s46, v99
    v_fmac_f32 v16, v24, v32
    v_fmac_f32 v17, v24, v33
    v_fmac_f32 v18, v24, v34
    v_fmac_f32 v19, v24, v35
    v_fmac_f32 v20, v24, v36
    v_fmac_f32 v21, v24, v37
    v_fmac_f32 v22, v24, v38
    v_fmac_f32 v23, v24, v39
    v_lshlrev_b32 v40, 16, v100
    v_and_b32 v41, s46, v100
    v_lshlrev_b32 v42, 16, v101
    v_and_b32 v43, s46, v101
    v_lshlrev_b32 v44, 16, v102
    v_and_b32 v45, s46, v102
    v_lshlrev_b32 v46, 16, v103
    v_and_b32 v47, s46, v103
    v_fmac_f32 v16, v25, v40
    v_fmac_f32 v17, v25, v41
    v_fmac_f32 v18, v25, v42
    v_fmac_f32 v19, v25, v43
    v_fmac_f32 v20, v25, v44
    v_fmac_f32 v21, v25, v45
    v_fmac_f32 v22, v25, v46
    v_fmac_f32 v23, v25, v47
    v_lshlrev_b32 v32, 16, v104
    v_and_b32 v33, s46, v104
    v_lshlrev_b32 v34, 16, v105
    v_and_b32 v35, s46, v105
    v_lshlrev_b32 v36, 16, v106
    v_and_b32 v37, s46, v106
    v_lshlrev_b32 v38, 16, v107
    v_and_b32 v39, s46, v107
    v_fmac_f32 v16, v26, v32
    v_fmac_f32 v17, v26, v33
    v_fmac_f32 v18, v26, v34
    v_fmac_f32 v19, v26, v35
    v_fmac_f32 v20, v26, v36
    v_fmac_f32 v21, v26, v37
    v_fmac_f32 v22, v26, v38
    v_fmac_f32 v23, v26, v39
    v_lshlrev_b32 v40, 16, v108
    v_and_b32 v41, s46, v108
    v_lshlrev_b32 v42, 16, v109
    v_and_b32 v43, s46, v109
    v_lshlrev_b32 v44, 16, v110
    v_and_b32 v45, s46, v110
    v_lshlrev_b32 v46, 16, v111
    v_and_b32 v47, s46, v111
    v_fmac_f32 v16, v27, v40
    v_fmac_f32 v17, v27, v41
    v_fmac_f32 v18, v27, v42
    v_fmac_f32 v19, v27, v43
    v_fmac_f32 v20, v27, v44
    v_fmac_f32 v21, v27, v45
    v_fmac_f32 v22, v27, v46
    v_fmac_f32 v23, v27, v47
    v_lshlrev_b32 v32, 16, v112
    v_and_b32 v33, s46, v112
    v_lshlrev_b32 v34, 16, v113
    v_and_b32 v35, s46, v113
    v_lshlrev_b32 v36, 16, v114
    v_and_b32 v37, s46, v114
    v_lshlrev_b32 v38, 16, v115
    v_and_b32 v39, s46, v115
    v_fmac_f32 v16, v28, v32
    v_fmac_f32 v17, v28, v33
    v_fmac_f32 v18, v28, v34
    v_fmac_f32 v19, v28, v35
    v_fmac_f32 v20, v28, v36
    v_fmac_f32 v21, v28, v37
    v_fmac_f32 v22, v28, v38
    v_fmac_f32 v23, v28, v39
    v_lshlrev_b32 v40, 16, v116
    v_and_b32 v41, s46, v116
    v_lshlrev_b32 v42, 16, v117
    v_and_b32 v43, s46, v117
    v_lshlrev_b32 v44, 16, v118
    v_and_b32 v45, s46, v118
    v_lshlrev_b32 v46, 16, v119
    v_and_b32 v47, s46, v119
    v_fmac_f32 v16, v29, v40
    v_fmac_f32 v17, v29, v41
    v_fmac_f32 v18, v29, v42
    v_fmac_f32 v19, v29, v43
    v_fmac_f32 v20, v29, v44
    v_fmac_f32 v21, v29, v45
    v_fmac_f32 v22, v29, v46
    v_fmac_f32 v23, v29, v47
    v_lshlrev_b32 v32, 16, v120
    v_and_b32 v33, s46, v120
    v_lshlrev_b32 v34, 16, v121
    v_and_b32 v35, s46, v121
    v_lshlrev_b32 v36, 16, v122
    v_and_b32 v37, s46, v122
    v_lshlrev_b32 v38, 16, v123
    v_and_b32 v39, s46, v123
    v_fmac_f32 v16, v30, v32
    v_fmac_f32 v17, v30, v33
    v_fmac_f32 v18, v30, v34
    v_fmac_f32 v19, v30, v35
    v_fmac_f32 v20, v30, v36
    v_fmac_f32 v21, v30, v37
    v_fmac_f32 v22, v30, v38
    v_fmac_f32 v23, v30, v39
    v_lshlrev_b32 v40, 16, v124
    v_and_b32 v41, s46, v124
    v_lshlrev_b32 v42, 16, v125
    v_and_b32 v43, s46, v125
    v_lshlrev_b32 v44, 16, v126
    v_and_b32 v45, s46, v126
    v_lshlrev_b32 v46, 16, v127
    v_and_b32 v47, s46, v127
    v_fmac_f32 v16, v31, v40
    v_fmac_f32 v17, v31, v41
    v_fmac_f32 v18, v31, v42
    v_fmac_f32 v19, v31, v43
    v_fmac_f32 v20, v31, v44
    v_fmac_f32 v21, v31, v45
    v_fmac_f32 v22, v31, v46
    v_fmac_f32 v23, v31, v47
    global_load_dwordx4 v[96:99], v4, s[38:39] offset:0 nt
    global_load_dwordx4 v[100:103], v4, s[38:39] offset:256 nt
    global_load_dwordx4 v[104:107], v4, s[38:39] offset:512 nt
    global_load_dwordx4 v[108:111], v4, s[38:39] offset:768 nt
    global_load_dwordx4 v[112:115], v4, s[38:39] offset:1024 nt
    global_load_dwordx4 v[116:119], v4, s[38:39] offset:1280 nt
    global_load_dwordx4 v[120:123], v4, s[38:39] offset:1536 nt
    global_load_dwordx4 v[124:127], v4, s[38:39] offset:1792 nt
    v_add_u32 v4, 65536, v4
    s_waitcnt vmcnt(24)
    v_dot2_f32_bf16 v24, v128, v8, 0
    v_dot2_f32_bf16 v25, v132, v8, 0
    v_dot2_f32_bf16 v26, v136, v8, 0
    v_dot2_f32_bf16 v27, v140, v8, 0
    v_dot2_f32_bf16 v28, v144, v8, 0
    v_dot2_f32_bf16 v29, v148, v8, 0
    v_dot2_f32_bf16 v30, v152, v8, 0
    v_dot2_f32_bf16 v31, v156, v8, 0
    v_dot2_f32_bf16 v24, v129, v9, v24
    v_dot2_f32_bf16 v25, v133, v9, v25
    v_dot2_f32_bf16 v26, v137, v9, v26
    v_dot2_f32_bf16 v27, v141, v9, v27
    v_dot2_f32_bf16 v28, v145, v9, v28
    v_dot2_f32_bf16 v29, v149, v9, v29
    v_dot2_f32_bf16 v30, v153, v9, v30
    v_dot2_f32_bf16 v31, v157, v9, v31
    v_dot2_f32_bf16 v24, v130, v10, v24
    v_dot2_f32_bf16 v25, v134, v10, v25
    v_dot2_f32_bf16 v26, v138, v10, v26
    v_dot2_f32_bf16 v27, v142, v10, v27
    v_dot2_f32_bf16 v28, v146, v10, v28
    v_dot2_f32_bf16 v29, v150, v10, v29
    v_dot2_f32_bf16 v30, v154, v10, v30
    v_dot2_f32_bf16 v31, v158, v10, v31
    v_dot2_f32_bf16 v24, v131, v11, v24
    v_dot2_f32_bf16 v25, v135, v11, v25
    v_dot2_f32_bf16 v26, v139, v11, v26
    v_dot2_f32_bf16 v27, v143, v11, v27
    v_dot2_f32_bf16 v28, v147, v11, v28
    v_dot2_f32_bf16 v29, v151, v11, v29
    v_dot2_f32_bf16 v30, v155, v11, v30
    v_dot2_f32_bf16 v31, v159, v11, v31
    global_load_dwordx4 v[128:131], v4, s[36:37] offset:0 nt
    global_load_dwordx4 v[132:135], v4, s[36:37] offset:256 nt
    global_load_dwordx4 v[136:139], v4, s[36:37] offset:512 nt
    global_load_dwordx4 v[140:143], v4, s[36:37] offset:768 nt
    global_load_dwordx4 v[144:147], v4, s[36:37] offset:1024 nt
    global_load_dwordx4 v[148:151], v4, s[36:37] offset:1280 nt
    global_load_dwordx4 v[152:155], v4, s[36:37] offset:1536 nt
    global_load_dwordx4 v[156:159], v4, s[36:37] offset:1792 nt
    v_add_f32_dpp v24, v24, v24 row_ror:8 row_mask:0xf bank_mask:0xf
    v_add_f32_dpp v25, v25, v25 row_ror:8 row_mask:0xf bank_mask:0xf
    v_add_f32_dpp v26, v26, v26 row_ror:8 row_mask:0xf bank_mask:0xf
    v_add_f32_dpp v27, v27, v27 row_ror:8 row_mask:0xf bank_mask:0xf
    v_add_f32_dpp v28, v28, v28 row_ror:8 row_mask:0xf bank_mask:0xf
    v_add_f32_dpp v29, v29, v29 row_ror:8 row_mask:0xf bank_mask:0xf
    v_add_f32_dpp v30, v30, v30 row_ror:8 row_mask:0xf bank_mask:0xf
    v_add_f32_dpp v31, v31, v31 row_ror:8 row_mask:0xf bank_mask:0xf
    v_add_f32_dpp v24, v24, v24 row_ror:4 row_mask:0xf bank_mask:0xf
    v_add_f32_dpp v25, v25, v25 row_ror:4 row_mask:0xf bank_mask:0xf
    v_add_f32_dpp v26, v26, v26 row_ror:4 row_mask:0xf bank_mask:0xf
    v_add_f32_dpp v27, v27, v27 row_ror:4 row_mask:0xf bank_mask:0xf
    v_add_f32_dpp v28, v28, v28 row_ror:4 row_mask:0xf bank_mask:0xf
    v_add_f32_dpp v29, v29, v29 row_ror:4 row_mask:0xf bank_mask:0xf
    v_add_f32_dpp v30, v30, v30 row_ror:4 row_mask:0xf bank_mask:0xf
    v_add_f32_dpp v31, v31, v31 row_ror:4 row_mask:0xf bank_mask:0xf
    v_add_f32_dpp v24, v24, v24 row_ror:2 row_mask:0xf bank_mask:0xf
    v_add_f32_dpp v25, v25, v25 row_ror:2 row_mask:0xf bank_mask:0xf
    v_add_f32_dpp v26, v26, v26 row_ror:2 row_mask:0xf bank_mask:0xf
    v_add_f32_dpp v27, v27, v27 row_ror:2 row_mask:0xf bank_mask:0xf
    v_add_f32_dpp v28, v28, v28 row_ror:2 row_mask:0xf bank_mask:0xf
    v_add_f32_dpp v29, v29, v29 row_ror:2 row_mask:0xf bank_mask:0xf
    v_add_f32_dpp v30, v30, v30 row_ror:2 row_mask:0xf bank_mask:0xf
    v_add_f32_dpp v31, v31, v31 row_ror:2 row_mask:0xf bank_mask:0xf
    v_add_f32_dpp v24, v24, v24 row_ror:1 row_mask:0xf bank_mask:0xf
    v_add_f32_dpp v25, v25, v25 row_ror:1 row_mask:0xf bank_mask:0xf
    v_add_f32_dpp v26, v26, v26 row_ror:1 row_mask:0xf bank_mask:0xf
    v_add_f32_dpp v27, v27, v27 row_ror:1 row_mask:0xf bank_mask:0xf
    v_add_f32_dpp v28, v28, v28 row_ror:1 row_mask:0xf bank_mask:0xf
    v_add_f32_dpp v29, v29, v29 row_ror:1 row_mask:0xf bank_mask:0xf
    v_add_f32_dpp v30, v30, v30 row_ror:1 row_mask:0xf bank_mask:0xf
    v_add_f32_dpp v31, v31, v31 row_ror:1 row_mask:0xf bank_mask:0xf
    v_cvt_pk_bf16_f32 v32, v24, v25
    v_cvt_pk_bf16_f32 v33, v26, v27
    v_cvt_pk_bf16_f32 v34, v28, v29
    v_cvt_pk_bf16_f32 v35, v30, v31
    v_lshlrev_b32 v24, 16, v32
    v_and_b32 v25, s46, v32
    v_lshlrev_b32 v26, 16, v33
    v_and_b32 v27, s46, v33
    v_lshlrev_b32 v28, 16, v34
    v_and_b32 v29, s46, v34
    v_lshlrev_b32 v30, 16, v35
    v_and_b32 v31, s46, v35
    v_mul_f32 v24, s44, v24
    v_mul_f32 v25, s44, v25
    v_mul_f32 v26, s44, v26
    v_mul_f32 v27, s44, v27
    v_mul_f32 v28, s44, v28
    v_mul_f32 v29, s44, v29
    v_mul_f32 v30, s44, v30
    v_mul_f32 v31, s44, v31
    v_cvt_pk_bf16_f32 v32, v24, v25
    v_cvt_pk_bf16_f32 v33, v26, v27
    v_cvt_pk_bf16_f32 v34, v28, v29
    v_cvt_pk_bf16_f32 v35, v30, v31
    v_lshlrev_b32 v24, 16, v32
    v_and_b32 v25, s46, v32
    v_lshlrev_b32 v26, 16, v33
    v_and_b32 v27, s46, v33
    v_lshlrev_b32 v28, 16, v34
    v_and_b32 v29, s46, v34
    v_lshlrev_b32 v30, 16, v35
    v_and_b32 v31, s46, v35
    v_max3_f32 v32, v24, v25, v26
    v_max3_f32 v33, v27, v28, v29
    v_max3_f32 v34, v30, v31, v12
    v_max3_f32 v12, v32, v33, v34
    v_mul_f32 v15, s45, v12
    v_sub_f32 v35, v14, v15
    v_exp_f32 v35, v35
    v_mov_b32 v14, v15
    v_fma_f32 v24, v24, s45, -v15
    v_fma_f32 v25, v25, s45, -v15
    v_fma_f32 v26, v26, s45, -v15
    v_fma_f32 v27, v27, s45, -v15
    v_fma_f32 v28, v28, s45, -v15
    v_fma_f32 v29, v29, s45, -v15
    v_fma_f32 v30, v30, s45, -v15
    v_fma_f32 v31, v31, s45, -v15
    v_exp_f32 v24, v24
    v_exp_f32 v25, v25
    v_exp_f32 v26, v26
    v_exp_f32 v27, v27
    v_exp_f32 v28, v28
    v_exp_f32 v29, v29
    v_exp_f32 v30, v30
    v_exp_f32 v31, v31
    v_mul_f32 v13, v13, v35
    v_mul_f32 v16, v16, v35
    v_mul_f32 v17, v17, v35
    v_mul_f32 v18, v18, v35
    v_mul_f32 v19, v19, v35
    v_mul_f32 v20, v20, v35
    v_mul_f32 v21, v21, v35
    v_mul_f32 v22, v22, v35
    v_mul_f32 v23, v23, v35
    v_add_f32 v36, v24, v25
    v_add_f32 v37, v26, v27
    v_add_f32 v38, v28, v29
    v_add_f32 v39, v30, v31
    v_add_f32 v36, v36, v37
    v_add_f32 v38, v38, v39
    v_add_f32 v36, v36, v38
    v_add_f32 v13, v13, v36
    s_waitcnt vmcnt(24)
    v_lshlrev_b32 v32, 16, v160
    v_and_b32 v33, s46, v160
    v_lshlrev_b32 v34, 16, v161
    v_and_b32 v35, s46, v161
    v_lshlrev_b32 v36, 16, v162
    v_and_b32 v37, s46, v162
    v_lshlrev_b32 v38, 16, v163
    v_and_b32 v39, s46, v163
    v_fmac_f32 v16, v24, v32
    v_fmac_f32 v17, v24, v33
    v_fmac_f32 v18, v24, v34
    v_fmac_f32 v19, v24, v35
    v_fmac_f32 v20, v24, v36
    v_fmac_f32 v21, v24, v37
    v_fmac_f32 v22, v24, v38
    v_fmac_f32 v23, v24, v39
    v_lshlrev_b32 v40, 16, v164
    v_and_b32 v41, s46, v164
    v_lshlrev_b32 v42, 16, v165
    v_and_b32 v43, s46, v165
    v_lshlrev_b32 v44, 16, v166
    v_and_b32 v45, s46, v166
    v_lshlrev_b32 v46, 16, v167
    v_and_b32 v47, s46, v167
    v_fmac_f32 v16, v25, v40
    v_fmac_f32 v17, v25, v41
    v_fmac_f32 v18, v25, v42
    v_fmac_f32 v19, v25, v43
    v_fmac_f32 v20, v25, v44
    v_fmac_f32 v21, v25, v45
    v_fmac_f32 v22, v25, v46
    v_fmac_f32 v23, v25, v47
    v_lshlrev_b32 v32, 16, v168
    v_and_b32 v33, s46, v168
    v_lshlrev_b32 v34, 16, v169
    v_and_b32 v35, s46, v169
    v_lshlrev_b32 v36, 16, v170
    v_and_b32 v37, s46, v170
    v_lshlrev_b32 v38, 16, v171
    v_and_b32 v39, s46, v171
    v_fmac_f32 v16, v26, v32
    v_fmac_f32 v17, v26, v33
    v_fmac_f32 v18, v26, v34
    v_fmac_f32 v19, v26, v35
    v_fmac_f32 v20, v26, v36
    v_fmac_f32 v21, v26, v37
    v_fmac_f32 v22, v26, v38
    v_fmac_f32 v23, v26, v39
    v_lshlrev_b32 v40, 16, v172
    v_and_b32 v41, s46, v172
    v_lshlrev_b32 v42, 16, v173
    v_and_b32 v43, s46, v173
    v_lshlrev_b32 v44, 16, v174
    v_and_b32 v45, s46, v174
    v_lshlrev_b32 v46, 16, v175
    v_and_b32 v47, s46, v175
    v_fmac_f32 v16, v27, v40
    v_fmac_f32 v17, v27, v41
    v_fmac_f32 v18, v27, v42
    v_fmac_f32 v19, v27, v43
    v_fmac_f32 v20, v27, v44
    v_fmac_f32 v21, v27, v45
    v_fmac_f32 v22, v27, v46
    v_fmac_f32 v23, v27, v47
    v_lshlrev_b32 v32, 16, v176
    v_and_b32 v33, s46, v176
    v_lshlrev_b32 v34, 16, v177
    v_and_b32 v35, s46, v177
    v_lshlrev_b32 v36, 16, v178
    v_and_b32 v37, s46, v178
    v_lshlrev_b32 v38, 16, v179
    v_and_b32 v39, s46, v179
    v_fmac_f32 v16, v28, v32
    v_fmac_f32 v17, v28, v33
    v_fmac_f32 v18, v28, v34
    v_fmac_f32 v19, v28, v35
    v_fmac_f32 v20, v28, v36
    v_fmac_f32 v21, v28, v37
    v_fmac_f32 v22, v28, v38
    v_fmac_f32 v23, v28, v39
    v_lshlrev_b32 v40, 16, v180
    v_and_b32 v41, s46, v180
    v_lshlrev_b32 v42, 16, v181
    v_and_b32 v43, s46, v181
    v_lshlrev_b32 v44, 16, v182
    v_and_b32 v45, s46, v182
    v_lshlrev_b32 v46, 16, v183
    v_and_b32 v47, s46, v183
    v_fmac_f32 v16, v29, v40
    v_fmac_f32 v17, v29, v41
    v_fmac_f32 v18, v29, v42
    v_fmac_f32 v19, v29, v43
    v_fmac_f32 v20, v29, v44
    v_fmac_f32 v21, v29, v45
    v_fmac_f32 v22, v29, v46
    v_fmac_f32 v23, v29, v47
    v_lshlrev_b32 v32, 16, v184
    v_and_b32 v33, s46, v184
    v_lshlrev_b32 v34, 16, v185
    v_and_b32 v35, s46, v185
    v_lshlrev_b32 v36, 16, v186
    v_and_b32 v37, s46, v186
    v_lshlrev_b32 v38, 16, v187
    v_and_b32 v39, s46, v187
    v_fmac_f32 v16, v30, v32
    v_fmac_f32 v17, v30, v33
    v_fmac_f32 v18, v30, v34
    v_fmac_f32 v19, v30, v35
    v_fmac_f32 v20, v30, v36
    v_fmac_f32 v21, v30, v37
    v_fmac_f32 v22, v30, v38
    v_fmac_f32 v23, v30, v39
    v_lshlrev_b32 v40, 16, v188
    v_and_b32 v41, s46, v188
    v_lshlrev_b32 v42, 16, v189
    v_and_b32 v43, s46, v189
    v_lshlrev_b32 v44, 16, v190
    v_and_b32 v45, s46, v190
    v_lshlrev_b32 v46, 16, v191
    v_and_b32 v47, s46, v191
    v_fmac_f32 v16, v31, v40
    v_fmac_f32 v17, v31, v41
    v_fmac_f32 v18, v31, v42
    v_fmac_f32 v19, v31, v43
    v_fmac_f32 v20, v31, v44
    v_fmac_f32 v21, v31, v45
    v_fmac_f32 v22, v31, v46
    v_fmac_f32 v23, v31, v47
    global_load_dwordx4 v[160:163], v4, s[38:39] offset:0 nt
    global_load_dwordx4 v[164:167], v4, s[38:39] offset:256 nt
    global_load_dwordx4 v[168:171], v4, s[38:39] offset:512 nt
    global_load_dwordx4 v[172:175], v4, s[38:39] offset:768 nt
    global_load_dwordx4 v[176:179], v4, s[38:39] offset:1024 nt
    global_load_dwordx4 v[180:183], v4, s[38:39] offset:1280 nt
    global_load_dwordx4 v[184:187], v4, s[38:39] offset:1536 nt
    global_load_dwordx4 v[188:191], v4, s[38:39] offset:1792 nt
    v_add_u32 v4, 65536, v4
    s_add_u32 s47, s47, 1
    s_cmp_lt_u32 s47, 5
    s_cbranch_scc1 L_loop
    s_mul_i32 s33, s32, 544
    s_add_u32 s33, s33, 16384
    v_and_b32 v5, 1, v3
    v_lshlrev_b32 v5, 1, v5
    v_lshrrev_b32 v7, 1, v3
    v_or_b32 v5, v5, v7
    v_lshl_add_u32 v7, v2, 3, v5
    v_lshlrev_b32 v7, 1, v7
    v_add_u32 v60, s33, v7
    v_mul_u32_u24 v61, 272, v2
    v_lshl_add_u32 v61, v3, 4, v61
    v_lshlrev_b32 v62, 4, v3
    s_lshl_b32 s33, s54, 6
    v_lshl_add_u32 v63, v5, 4, v2
    v_add_u32 v63, s33, v63
    v_lshlrev_b32 v63, 2, v63
    s_lshl_b32 s33, s43, 11
    s_add_u32 s34, s26, s33
    s_addc_u32 s35, s27, 0
    s_lshl_b32 s33, s43, 3
    s_add_u32 s33, s33, 524288
    s_add_u32 s40, s26, s33
    s_addc_u32 s41, s27, 0
    s_lshl_b32 s33, s32, 3
    v_mov_b32 v59, s33
    v_mov_b32 v58, 0
    s_waitcnt vmcnt(24)
    v_dot2_f32_bf16 v24, v64, v8, 0
    v_dot2_f32_bf16 v25, v68, v8, 0
    v_dot2_f32_bf16 v26, v72, v8, 0
    v_dot2_f32_bf16 v27, v76, v8, 0
    v_dot2_f32_bf16 v28, v80, v8, 0
    v_dot2_f32_bf16 v29, v84, v8, 0
    v_dot2_f32_bf16 v30, v88, v8, 0
    v_dot2_f32_bf16 v31, v92, v8, 0
    v_dot2_f32_bf16 v24, v65, v9, v24
    v_dot2_f32_bf16 v25, v69, v9, v25
    v_dot2_f32_bf16 v26, v73, v9, v26
    v_dot2_f32_bf16 v27, v77, v9, v27
    v_dot2_f32_bf16 v28, v81, v9, v28
    v_dot2_f32_bf16 v29, v85, v9, v29
    v_dot2_f32_bf16 v30, v89, v9, v30
    v_dot2_f32_bf16 v31, v93, v9, v31
    v_dot2_f32_bf16 v24, v66, v10, v24
    v_dot2_f32_bf16 v25, v70, v10, v25
    v_dot2_f32_bf16 v26, v74, v10, v26
    v_dot2_f32_bf16 v27, v78, v10, v27
    v_dot2_f32_bf16 v28, v82, v10, v28
    v_dot2_f32_bf16 v29, v86, v10, v29
    v_dot2_f32_bf16 v30, v90, v10, v30
    v_dot2_f32_bf16 v31, v94, v10, v31
    v_dot2_f32_bf16 v24, v67, v11, v24
    v_dot2_f32_bf16 v25, v71, v11, v25
    v_dot2_f32_bf16 v26, v75, v11, v26
    v_dot2_f32_bf16 v27, v79, v11, v27
    v_dot2_f32_bf16 v28, v83, v11, v28
    v_dot2_f32_bf16 v29, v87, v11, v29
    v_dot2_f32_bf16 v30, v91, v11, v30
    v_dot2_f32_bf16 v31, v95, v11, v31
    v_add_f32_dpp v24, v24, v24 row_ror:8 row_mask:0xf bank_mask:0xf
    v_add_f32_dpp v25, v25, v25 row_ror:8 row_mask:0xf bank_mask:0xf
    v_add_f32_dpp v26, v26, v26 row_ror:8 row_mask:0xf bank_mask:0xf
    v_add_f32_dpp v27, v27, v27 row_ror:8 row_mask:0xf bank_mask:0xf
    v_add_f32_dpp v28, v28, v28 row_ror:8 row_mask:0xf bank_mask:0xf
    v_add_f32_dpp v29, v29, v29 row_ror:8 row_mask:0xf bank_mask:0xf
    v_add_f32_dpp v30, v30, v30 row_ror:8 row_mask:0xf bank_mask:0xf
    v_add_f32_dpp v31, v31, v31 row_ror:8 row_mask:0xf bank_mask:0xf
    v_add_f32_dpp v24, v24, v24 row_ror:4 row_mask:0xf bank_mask:0xf
    v_add_f32_dpp v25, v25, v25 row_ror:4 row_mask:0xf bank_mask:0xf
    v_add_f32_dpp v26, v26, v26 row_ror:4 row_mask:0xf bank_mask:0xf
    v_add_f32_dpp v27, v27, v27 row_ror:4 row_mask:0xf bank_mask:0xf
    v_add_f32_dpp v28, v28, v28 row_ror:4 row_mask:0xf bank_mask:0xf
    v_add_f32_dpp v29, v29, v29 row_ror:4 row_mask:0xf bank_mask:0xf
    v_add_f32_dpp v30, v30, v30 row_ror:4 row_mask:0xf bank_mask:0xf
    v_add_f32_dpp v31, v31, v31 row_ror:4 row_mask:0xf bank_mask:0xf
    v_add_f32_dpp v24, v24, v24 row_ror:2 row_mask:0xf bank_mask:0xf
    v_add_f32_dpp v25, v25, v25 row_ror:2 row_mask:0xf bank_mask:0xf
    v_add_f32_dpp v26, v26, v26 row_ror:2 row_mask:0xf bank_mask:0xf
    v_add_f32_dpp v27, v27, v27 row_ror:2 row_mask:0xf bank_mask:0xf
    v_add_f32_dpp v28, v28, v28 row_ror:2 row_mask:0xf bank_mask:0xf
    v_add_f32_dpp v29, v29, v29 row_ror:2 row_mask:0xf bank_mask:0xf
    v_add_f32_dpp v30, v30, v30 row_ror:2 row_mask:0xf bank_mask:0xf
    v_add_f32_dpp v31, v31, v31 row_ror:2 row_mask:0xf bank_mask:0xf
    v_add_f32_dpp v24, v24, v24 row_ror:1 row_mask:0xf bank_mask:0xf
    v_add_f32_dpp v25, v25, v25 row_ror:1 row_mask:0xf bank_mask:0xf
    v_add_f32_dpp v26, v26, v26 row_ror:1 row_mask:0xf bank_mask:0xf
    v_add_f32_dpp v27, v27, v27 row_ror:1 row_mask:0xf bank_mask:0xf
    v_add_f32_dpp v28, v28, v28 row_ror:1 row_mask:0xf bank_mask:0xf
    v_add_f32_dpp v29, v29, v29 row_ror:1 row_mask:0xf bank_mask:0xf
    v_add_f32_dpp v30, v30, v30 row_ror:1 row_mask:0xf bank_mask:0xf
    v_add_f32_dpp v31, v31, v31 row_ror:1 row_mask:0xf bank_mask:0xf
    v_cvt_pk_bf16_f32 v32, v24, v25
    v_cvt_pk_bf16_f32 v33, v26, v27
    v_cvt_pk_bf16_f32 v34, v28, v29
    v_cvt_pk_bf16_f32 v35, v30, v31
    v_lshlrev_b32 v24, 16, v32
    v_and_b32 v25, s46, v32
    v_lshlrev_b32 v26, 16, v33
    v_and_b32 v27, s46, v33
    v_lshlrev_b32 v28, 16, v34
    v_and_b32 v29, s46, v34
    v_lshlrev_b32 v30, 16, v35
    v_and_b32 v31, s46, v35
    v_mul_f32 v24, s44, v24
    v_mul_f32 v25, s44, v25
    v_mul_f32 v26, s44, v26
    v_mul_f32 v27, s44, v27
    v_mul_f32 v28, s44, v28
    v_mul_f32 v29, s44, v29
    v_mul_f32 v30, s44, v30
    v_mul_f32 v31, s44, v31
    v_cvt_pk_bf16_f32 v32, v24, v25
    v_cvt_pk_bf16_f32 v33, v26, v27
    v_cvt_pk_bf16_f32 v34, v28, v29
    v_cvt_pk_bf16_f32 v35, v30, v31
    v_lshlrev_b32 v24, 16, v32
    v_and_b32 v25, s46, v32
    v_lshlrev_b32 v26, 16, v33
    v_and_b32 v27, s46, v33
    v_lshlrev_b32 v28, 16, v34
    v_and_b32 v29, s46, v34
    v_lshlrev_b32 v30, 16, v35
    v_and_b32 v31, s46, v35
    v_max3_f32 v32, v24, v25, v26
    v_max3_f32 v33, v27, v28, v29
    v_max3_f32 v34, v30, v31, v12
    v_max3_f32 v12, v32, v33, v34
    v_mul_f32 v15, s45, v12
    v_sub_f32 v35, v14, v15
    v_exp_f32 v35, v35
    v_mov_b32 v14, v15
    v_fma_f32 v24, v24, s45, -v15
    v_fma_f32 v25, v25, s45, -v15
    v_fma_f32 v26, v26, s45, -v15
    v_fma_f32 v27, v27, s45, -v15
    v_fma_f32 v28, v28, s45, -v15
    v_fma_f32 v29, v29, s45, -v15
    v_fma_f32 v30, v30, s45, -v15
    v_fma_f32 v31, v31, s45, -v15
    v_exp_f32 v24, v24
    v_exp_f32 v25, v25
    v_exp_f32 v26, v26
    v_exp_f32 v27, v27
    v_exp_f32 v28, v28
    v_exp_f32 v29, v29
    v_exp_f32 v30, v30
    v_exp_f32 v31, v31
    v_mul_f32 v13, v13, v35
    v_mul_f32 v16, v16, v35
    v_mul_f32 v17, v17, v35
    v_mul_f32 v18, v18, v35
    v_mul_f32 v19, v19, v35
    v_mul_f32 v20, v20, v35
    v_mul_f32 v21, v21, v35
    v_mul_f32 v22, v22, v35
    v_mul_f32 v23, v23, v35
    v_add_f32 v36, v24, v25
    v_add_f32 v37, v26, v27
    v_add_f32 v38, v28, v29
    v_add_f32 v39, v30, v31
    v_add_f32 v36, v36, v37
    v_add_f32 v38, v38, v39
    v_add_f32 v36, v36, v38
    v_add_f32 v13, v13, v36
    s_waitcnt vmcnt(16)
    v_lshlrev_b32 v32, 16, v96
    v_and_b32 v33, s46, v96
    v_lshlrev_b32 v34, 16, v97
    v_and_b32 v35, s46, v97
    v_lshlrev_b32 v36, 16, v98
    v_and_b32 v37, s46, v98
    v_lshlrev_b32 v38, 16, v99
    v_and_b32 v39, s46, v99
    v_fmac_f32 v16, v24, v32
    v_fmac_f32 v17, v24, v33
    v_fmac_f32 v18, v24, v34
    v_fmac_f32 v19, v24, v35
    v_fmac_f32 v20, v24, v36
    v_fmac_f32 v21, v24, v37
    v_fmac_f32 v22, v24, v38
    v_fmac_f32 v23, v24, v39
    v_lshlrev_b32 v40, 16, v100
    v_and_b32 v41, s46, v100
    v_lshlrev_b32 v42, 16, v101
    v_and_b32 v43, s46, v101
    v_lshlrev_b32 v44, 16, v102
    v_and_b32 v45, s46, v102
    v_lshlrev_b32 v46, 16, v103
    v_and_b32 v47, s46, v103
    v_fmac_f32 v16, v25, v40
    v_fmac_f32 v17, v25, v41
    v_fmac_f32 v18, v25, v42
    v_fmac_f32 v19, v25, v43
    v_fmac_f32 v20, v25, v44
    v_fmac_f32 v21, v25, v45
    v_fmac_f32 v22, v25, v46
    v_fmac_f32 v23, v25, v47
    v_lshlrev_b32 v32, 16, v104
    v_and_b32 v33, s46, v104
    v_lshlrev_b32 v34, 16, v105
    v_and_b32 v35, s46, v105
    v_lshlrev_b32 v36, 16, v106
    v_and_b32 v37, s46, v106
    v_lshlrev_b32 v38, 16, v107
    v_and_b32 v39, s46, v107
    v_fmac_f32 v16, v26, v32
    v_fmac_f32 v17, v26, v33
    v_fmac_f32 v18, v26, v34
    v_fmac_f32 v19, v26, v35
    v_fmac_f32 v20, v26, v36
    v_fmac_f32 v21, v26, v37
    v_fmac_f32 v22, v26, v38
    v_fmac_f32 v23, v26, v39
    v_lshlrev_b32 v40, 16, v108
    v_and_b32 v41, s46, v108
    v_lshlrev_b32 v42, 16, v109
    v_and_b32 v43, s46, v109
    v_lshlrev_b32 v44, 16, v110
    v_and_b32 v45, s46, v110
    v_lshlrev_b32 v46, 16, v111
    v_and_b32 v47, s46, v111
    v_fmac_f32 v16, v27, v40
    v_fmac_f32 v17, v27, v41
    v_fmac_f32 v18, v27, v42
    v_fmac_f32 v19, v27, v43
    v_fmac_f32 v20, v27, v44
    v_fmac_f32 v21, v27, v45
    v_fmac_f32 v22, v27, v46
    v_fmac_f32 v23, v27, v47
    v_lshlrev_b32 v32, 16, v112
    v_and_b32 v33, s46, v112
    v_lshlrev_b32 v34, 16, v113
    v_and_b32 v35, s46, v113
    v_lshlrev_b32 v36, 16, v114
    v_and_b32 v37, s46, v114
    v_lshlrev_b32 v38, 16, v115
    v_and_b32 v39, s46, v115
    v_fmac_f32 v16, v28, v32
    v_fmac_f32 v17, v28, v33
    v_fmac_f32 v18, v28, v34
    v_fmac_f32 v19, v28, v35
    v_fmac_f32 v20, v28, v36
    v_fmac_f32 v21, v28, v37
    v_fmac_f32 v22, v28, v38
    v_fmac_f32 v23, v28, v39
    v_lshlrev_b32 v40, 16, v116
    v_and_b32 v41, s46, v116
    v_lshlrev_b32 v42, 16, v117
    v_and_b32 v43, s46, v117
    v_lshlrev_b32 v44, 16, v118
    v_and_b32 v45, s46, v118
    v_lshlrev_b32 v46, 16, v119
    v_and_b32 v47, s46, v119
    v_fmac_f32 v16, v29, v40
    v_fmac_f32 v17, v29, v41
    v_fmac_f32 v18, v29, v42
    v_fmac_f32 v19, v29, v43
    v_fmac_f32 v20, v29, v44
    v_fmac_f32 v21, v29, v45
    v_fmac_f32 v22, v29, v46
    v_fmac_f32 v23, v29, v47
    v_lshlrev_b32 v32, 16, v120
    v_and_b32 v33, s46, v120
    v_lshlrev_b32 v34, 16, v121
    v_and_b32 v35, s46, v121
    v_lshlrev_b32 v36, 16, v122
    v_and_b32 v37, s46, v122
    v_lshlrev_b32 v38, 16, v123
    v_and_b32 v39, s46, v123
    v_fmac_f32 v16, v30, v32
    v_fmac_f32 v17, v30, v33
    v_fmac_f32 v18, v30, v34
    v_fmac_f32 v19, v30, v35
    v_fmac_f32 v20, v30, v36
    v_fmac_f32 v21, v30, v37
    v_fmac_f32 v22, v30, v38
    v_fmac_f32 v23, v30, v39
    v_lshlrev_b32 v40, 16, v124
    v_and_b32 v41, s46, v124
    v_lshlrev_b32 v42, 16, v125
    v_and_b32 v43, s46, v125
    v_lshlrev_b32 v44, 16, v126
    v_and_b32 v45, s46, v126
    v_lshlrev_b32 v46, 16, v127
    v_and_b32 v47, s46, v127
    v_fmac_f32 v16, v31, v40
    v_fmac_f32 v17, v31, v41
    v_fmac_f32 v18, v31, v42
    v_fmac_f32 v19, v31, v43
    v_fmac_f32 v20, v31, v44
    v_fmac_f32 v21, v31, v45
    v_fmac_f32 v22, v31, v46
    v_fmac_f32 v23, v31, v47
    s_waitcnt vmcnt(8)
    v_dot2_f32_bf16 v24, v128, v8, 0
    v_dot2_f32_bf16 v25, v132, v8, 0
    v_dot2_f32_bf16 v26, v136, v8, 0
    v_dot2_f32_bf16 v27, v140, v8, 0
    v_dot2_f32_bf16 v28, v144, v8, 0
    v_dot2_f32_bf16 v29, v148, v8, 0
    v_dot2_f32_bf16 v30, v152, v8, 0
    v_dot2_f32_bf16 v31, v156, v8, 0
    v_dot2_f32_bf16 v24, v129, v9, v24
    v_dot2_f32_bf16 v25, v133, v9, v25
    v_dot2_f32_bf16 v26, v137, v9, v26
    v_dot2_f32_bf16 v27, v141, v9, v27
    v_dot2_f32_bf16 v28, v145, v9, v28
    v_dot2_f32_bf16 v29, v149, v9, v29
    v_dot2_f32_bf16 v30, v153, v9, v30
    v_dot2_f32_bf16 v31, v157, v9, v31
    v_dot2_f32_bf16 v24, v130, v10, v24
    v_dot2_f32_bf16 v25, v134, v10, v25
    v_dot2_f32_bf16 v26, v138, v10, v26
    v_dot2_f32_bf16 v27, v142, v10, v27
    v_dot2_f32_bf16 v28, v146, v10, v28
    v_dot2_f32_bf16 v29, v150, v10, v29
    v_dot2_f32_bf16 v30, v154, v10, v30
    v_dot2_f32_bf16 v31, v158, v10, v31
    v_dot2_f32_bf16 v24, v131, v11, v24
    v_dot2_f32_bf16 v25, v135, v11, v25
    v_dot2_f32_bf16 v26, v139, v11, v26
    v_dot2_f32_bf16 v27, v143, v11, v27
    v_dot2_f32_bf16 v28, v147, v11, v28
    v_dot2_f32_bf16 v29, v151, v11, v29
    v_dot2_f32_bf16 v30, v155, v11, v30
    v_dot2_f32_bf16 v31, v159, v11, v31
    v_add_f32_dpp v24, v24, v24 row_ror:8 row_mask:0xf bank_mask:0xf
    v_add_f32_dpp v25, v25, v25 row_ror:8 row_mask:0xf bank_mask:0xf
    v_add_f32_dpp v26, v26, v26 row_ror:8 row_mask:0xf bank_mask:0xf
    v_add_f32_dpp v27, v27, v27 row_ror:8 row_mask:0xf bank_mask:0xf
    v_add_f32_dpp v28, v28, v28 row_ror:8 row_mask:0xf bank_mask:0xf
    v_add_f32_dpp v29, v29, v29 row_ror:8 row_mask:0xf bank_mask:0xf
    v_add_f32_dpp v30, v30, v30 row_ror:8 row_mask:0xf bank_mask:0xf
    v_add_f32_dpp v31, v31, v31 row_ror:8 row_mask:0xf bank_mask:0xf
    v_add_f32_dpp v24, v24, v24 row_ror:4 row_mask:0xf bank_mask:0xf
    v_add_f32_dpp v25, v25, v25 row_ror:4 row_mask:0xf bank_mask:0xf
    v_add_f32_dpp v26, v26, v26 row_ror:4 row_mask:0xf bank_mask:0xf
    v_add_f32_dpp v27, v27, v27 row_ror:4 row_mask:0xf bank_mask:0xf
    v_add_f32_dpp v28, v28, v28 row_ror:4 row_mask:0xf bank_mask:0xf
    v_add_f32_dpp v29, v29, v29 row_ror:4 row_mask:0xf bank_mask:0xf
    v_add_f32_dpp v30, v30, v30 row_ror:4 row_mask:0xf bank_mask:0xf
    v_add_f32_dpp v31, v31, v31 row_ror:4 row_mask:0xf bank_mask:0xf
    v_add_f32_dpp v24, v24, v24 row_ror:2 row_mask:0xf bank_mask:0xf
    v_add_f32_dpp v25, v25, v25 row_ror:2 row_mask:0xf bank_mask:0xf
    v_add_f32_dpp v26, v26, v26 row_ror:2 row_mask:0xf bank_mask:0xf
    v_add_f32_dpp v27, v27, v27 row_ror:2 row_mask:0xf bank_mask:0xf
    v_add_f32_dpp v28, v28, v28 row_ror:2 row_mask:0xf bank_mask:0xf
    v_add_f32_dpp v29, v29, v29 row_ror:2 row_mask:0xf bank_mask:0xf
    v_add_f32_dpp v30, v30, v30 row_ror:2 row_mask:0xf bank_mask:0xf
    v_add_f32_dpp v31, v31, v31 row_ror:2 row_mask:0xf bank_mask:0xf
    v_add_f32_dpp v24, v24, v24 row_ror:1 row_mask:0xf bank_mask:0xf
    v_add_f32_dpp v25, v25, v25 row_ror:1 row_mask:0xf bank_mask:0xf
    v_add_f32_dpp v26, v26, v26 row_ror:1 row_mask:0xf bank_mask:0xf
    v_add_f32_dpp v27, v27, v27 row_ror:1 row_mask:0xf bank_mask:0xf
    v_add_f32_dpp v28, v28, v28 row_ror:1 row_mask:0xf bank_mask:0xf
    v_add_f32_dpp v29, v29, v29 row_ror:1 row_mask:0xf bank_mask:0xf
    v_add_f32_dpp v30, v30, v30 row_ror:1 row_mask:0xf bank_mask:0xf
    v_add_f32_dpp v31, v31, v31 row_ror:1 row_mask:0xf bank_mask:0xf
    v_cvt_pk_bf16_f32 v32, v24, v25
    v_cvt_pk_bf16_f32 v33, v26, v27
    v_cvt_pk_bf16_f32 v34, v28, v29
    v_cvt_pk_bf16_f32 v35, v30, v31
    v_lshlrev_b32 v24, 16, v32
    v_and_b32 v25, s46, v32
    v_lshlrev_b32 v26, 16, v33
    v_and_b32 v27, s46, v33
    v_lshlrev_b32 v28, 16, v34
    v_and_b32 v29, s46, v34
    v_lshlrev_b32 v30, 16, v35
    v_and_b32 v31, s46, v35
    v_mul_f32 v24, s44, v24
    v_mul_f32 v25, s44, v25
    v_mul_f32 v26, s44, v26
    v_mul_f32 v27, s44, v27
    v_mul_f32 v28, s44, v28
    v_mul_f32 v29, s44, v29
    v_mul_f32 v30, s44, v30
    v_mul_f32 v31, s44, v31
    v_cvt_pk_bf16_f32 v32, v24, v25
    v_cvt_pk_bf16_f32 v33, v26, v27
    v_cvt_pk_bf16_f32 v34, v28, v29
    v_cvt_pk_bf16_f32 v35, v30, v31
    v_lshlrev_b32 v24, 16, v32
    v_and_b32 v25, s46, v32
    v_lshlrev_b32 v26, 16, v33
    v_and_b32 v27, s46, v33
    v_lshlrev_b32 v28, 16, v34
    v_and_b32 v29, s46, v34
    v_lshlrev_b32 v30, 16, v35
    v_and_b32 v31, s46, v35
    v_max3_f32 v32, v24, v25, v26
    v_max3_f32 v33, v27, v28, v29
    v_max3_f32 v34, v30, v31, v12
    v_max3_f32 v12, v32, v33, v34
    v_mul_f32 v15, s45, v12
    v_sub_f32 v35, v14, v15
    v_exp_f32 v35, v35
    v_mov_b32 v14, v15
    v_fma_f32 v24, v24, s45, -v15
    v_fma_f32 v25, v25, s45, -v15
    v_fma_f32 v26, v26, s45, -v15
    v_fma_f32 v27, v27, s45, -v15
    v_fma_f32 v28, v28, s45, -v15
    v_fma_f32 v29, v29, s45, -v15
    v_fma_f32 v30, v30, s45, -v15
    v_fma_f32 v31, v31, s45, -v15
    v_exp_f32 v24, v24
    v_exp_f32 v25, v25
    v_exp_f32 v26, v26
    v_exp_f32 v27, v27
    v_exp_f32 v28, v28
    v_exp_f32 v29, v29
    v_exp_f32 v30, v30
    v_exp_f32 v31, v31
    v_mul_f32 v13, v13, v35
    v_mul_f32 v16, v16, v35
    v_mul_f32 v17, v17, v35
    v_mul_f32 v18, v18, v35
    v_mul_f32 v19, v19, v35
    v_mul_f32 v20, v20, v35
    v_mul_f32 v21, v21, v35
    v_mul_f32 v22, v22, v35
    v_mul_f32 v23, v23, v35
    v_add_f32 v36, v24, v25
    v_add_f32 v37, v26, v27
    v_add_f32 v38, v28, v29
    v_add_f32 v39, v30, v31
    v_add_f32 v36, v36, v37
    v_add_f32 v38, v38, v39
    v_add_f32 v36, v36, v38
    v_add_f32 v13, v13, v36
    s_waitcnt vmcnt(7)
    v_lshlrev_b32 v32, 16, v160
    v_and_b32 v33, s46, v160
    v_lshlrev_b32 v34, 16, v161
    v_and_b32 v35, s46, v161
    v_lshlrev_b32 v36, 16, v162
    v_and_b32 v37, s46, v162
    v_lshlrev_b32 v38, 16, v163
    v_and_b32 v39, s46, v163
    v_fmac_f32 v16, v24, v32
    v_fmac_f32 v17, v24, v33
    v_fmac_f32 v18, v24, v34
    v_fmac_f32 v19, v24, v35
    v_fmac_f32 v20, v24, v36
    v_fmac_f32 v21, v24, v37
    v_fmac_f32 v22, v24, v38
    v_fmac_f32 v23, v24, v39
    s_waitcnt vmcnt(6)
    v_lshlrev_b32 v40, 16, v164
    v_and_b32 v41, s46, v164
    v_lshlrev_b32 v42, 16, v165
    v_and_b32 v43, s46, v165
    v_lshlrev_b32 v44, 16, v166
    v_and_b32 v45, s46, v166
    v_lshlrev_b32 v46, 16, v167
    v_and_b32 v47, s46, v167
    v_fmac_f32 v16, v25, v40
    v_fmac_f32 v17, v25, v41
    v_fmac_f32 v18, v25, v42
    v_fmac_f32 v19, v25, v43
    v_fmac_f32 v20, v25, v44
    v_fmac_f32 v21, v25, v45
    v_fmac_f32 v22, v25, v46
    v_fmac_f32 v23, v25, v47
    s_waitcnt vmcnt(5)
    v_lshlrev_b32 v32, 16, v168
    v_and_b32 v33, s46, v168
    v_lshlrev_b32 v34, 16, v169
    v_and_b32 v35, s46, v169
    v_lshlrev_b32 v36, 16, v170
    v_and_b32 v37, s46, v170
    v_lshlrev_b32 v38, 16, v171
    v_and_b32 v39, s46, v171
    v_fmac_f32 v16, v26, v32
    v_fmac_f32 v17, v26, v33
    v_fmac_f32 v18, v26, v34
    v_fmac_f32 v19, v26, v35
    v_fmac_f32 v20, v26, v36
    v_fmac_f32 v21, v26, v37
    v_fmac_f32 v22, v26, v38
    v_fmac_f32 v23, v26, v39
    s_waitcnt vmcnt(4)
    v_lshlrev_b32 v40, 16, v172
    v_and_b32 v41, s46, v172
    v_lshlrev_b32 v42, 16, v173
    v_and_b32 v43, s46, v173
    v_lshlrev_b32 v44, 16, v174
    v_and_b32 v45, s46, v174
    v_lshlrev_b32 v46, 16, v175
    v_and_b32 v47, s46, v175
    v_fmac_f32 v16, v27, v40
    v_fmac_f32 v17, v27, v41
    v_fmac_f32 v18, v27, v42
    v_fmac_f32 v19, v27, v43
    v_fmac_f32 v20, v27, v44
    v_fmac_f32 v21, v27, v45
    v_fmac_f32 v22, v27, v46
    v_fmac_f32 v23, v27, v47
    s_waitcnt vmcnt(3)
    v_lshlrev_b32 v32, 16, v176
    v_and_b32 v33, s46, v176
    v_lshlrev_b32 v34, 16, v177
    v_and_b32 v35, s46, v177
    v_lshlrev_b32 v36, 16, v178
    v_and_b32 v37, s46, v178
    v_lshlrev_b32 v38, 16, v179
    v_and_b32 v39, s46, v179
    v_fmac_f32 v16, v28, v32
    v_fmac_f32 v17, v28, v33
    v_fmac_f32 v18, v28, v34
    v_fmac_f32 v19, v28, v35
    v_fmac_f32 v20, v28, v36
    v_fmac_f32 v21, v28, v37
    v_fmac_f32 v22, v28, v38
    v_fmac_f32 v23, v28, v39
    s_waitcnt vmcnt(2)
    v_lshlrev_b32 v40, 16, v180
    v_and_b32 v41, s46, v180
    v_lshlrev_b32 v42, 16, v181
    v_and_b32 v43, s46, v181
    v_lshlrev_b32 v44, 16, v182
    v_and_b32 v45, s46, v182
    v_lshlrev_b32 v46, 16, v183
    v_and_b32 v47, s46, v183
    v_fmac_f32 v16, v29, v40
    v_fmac_f32 v17, v29, v41
    v_fmac_f32 v18, v29, v42
    v_fmac_f32 v19, v29, v43
    v_fmac_f32 v20, v29, v44
    v_fmac_f32 v21, v29, v45
    v_fmac_f32 v22, v29, v46
    v_fmac_f32 v23, v29, v47
    s_waitcnt vmcnt(1)
    v_lshlrev_b32 v32, 16, v184
    v_and_b32 v33, s46, v184
    v_lshlrev_b32 v34, 16, v185
    v_and_b32 v35, s46, v185
    v_lshlrev_b32 v36, 16, v186
    v_and_b32 v37, s46, v186
    v_lshlrev_b32 v38, 16, v187
    v_and_b32 v39, s46, v187
    v_fmac_f32 v16, v30, v32
    v_fmac_f32 v17, v30, v33
    v_fmac_f32 v18, v30, v34
    v_fmac_f32 v19, v30, v35
    v_fmac_f32 v20, v30, v36
    v_fmac_f32 v21, v30, v37
    v_fmac_f32 v22, v30, v38
    v_fmac_f32 v23, v30, v39
    s_waitcnt vmcnt(0)
    v_lshlrev_b32 v40, 16, v188
    v_and_b32 v41, s46, v188
    v_lshlrev_b32 v42, 16, v189
    v_and_b32 v43, s46, v189
    v_lshlrev_b32 v44, 16, v190
    v_and_b32 v45, s46, v190
    v_lshlrev_b32 v46, 16, v191
    v_and_b32 v47, s46, v191
    v_fmac_f32 v16, v31, v40
    v_fmac_f32 v17, v31, v41
    v_fmac_f32 v18, v31, v42
    v_fmac_f32 v19, v31, v43
    v_fmac_f32 v20, v31, v44
    v_fmac_f32 v21, v31, v45
    v_fmac_f32 v22, v31, v46
    v_fmac_f32 v23, v31, v47
    v_mov_b32 v32, v14
    v_mov_b32 v33, v14
    s_nop 1
    v_permlane32_swap_b32 v32, v33
    v_max_f32 v32, v32, v33
    v_mov_b32 v33, v32
    s_nop 1
    v_permlane16_swap_b32 v32, v33
    v_max_f32 v34, v32, v33
    v_sub_f32 v32, v14, v34
    v_exp_f32 v32, v32
    s_nop 0
    v_mul_f32 v16, v16, v32
    v_mul_f32 v17, v17, v32
    v_mul_f32 v18, v18, v32
    v_mul_f32 v19, v19, v32
    v_mul_f32 v20, v20, v32
    v_mul_f32 v21, v21, v32
    v_mul_f32 v22, v22, v32
    v_mul_f32 v23, v23, v32
    v_mul_f32 v35, v13, v32
    v_mov_b32 v36, v35
    v_permlane32_swap_b32 v16, v17
    v_permlane32_swap_b32 v18, v19
    v_permlane32_swap_b32 v20, v21
    v_permlane32_swap_b32 v22, v23
    v_permlane32_swap_b32 v35, v36
    v_add_f32 v16, v16, v17
    v_add_f32 v18, v18, v19
    v_add_f32 v20, v20, v21
    v_add_f32 v22, v22, v23
    v_add_f32 v35, v35, v36
    v_mov_b32 v36, v35
    v_permlane16_swap_b32 v16, v18
    v_permlane16_swap_b32 v20, v22
    v_permlane16_swap_b32 v35, v36
    v_add_f32 v16, v16, v18
    v_add_f32 v20, v20, v22
    v_add_f32 v35, v35, v36
    v_cvt_pk_bf16_f32 v37, v16, v20
    v_lshlrev_b32 v38, 16, v37
    v_and_b32 v39, s46, v37
    v_sub_f32 v38, v16, v38
    v_sub_f32 v39, v20, v39
    v_cvt_pk_bf16_f32 v38, v38, v39
    ds_write_b16 v60, v37
    ds_write_b16_d16_hi v60, v37 offset:8
    ds_write_b16 v60, v38 offset:272
    ds_write_b16_d16_hi v60, v38 offset:280
    ds_write_b64 v59, v[34:35] offset:34816
    s_waitcnt lgkmcnt(0)
    s_barrier
    ds_read_b128 v[128:131], v61 offset:16384
    ds_read_b128 v[132:135], v61 offset:16448
    ds_read_b128 v[136:139], v61 offset:16512
    ds_read_b128 v[140:143], v61 offset:16576
    ds_read_b128 v[176:179], v62 offset:34816
    ds_read_b128 v[160:163], v58 offset:34816
    ds_read_b128 v[164:167], v58 offset:34832
    ds_read_b128 v[168:171], v58 offset:34848
    ds_read_b128 v[172:175], v58 offset:34864
    s_waitcnt lgkmcnt(8)
    v_mfma_f32_16x16x32_bf16 v[144:147], v[128:131], v[192:195], 0
    v_mfma_f32_16x16x32_bf16 v[148:151], v[128:131], v[196:199], 0
    v_mfma_f32_16x16x32_bf16 v[152:155], v[128:131], v[200:203], 0
    v_mfma_f32_16x16x32_bf16 v[156:159], v[128:131], v[204:207], 0
    s_waitcnt lgkmcnt(7)
    v_mfma_f32_16x16x32_bf16 v[144:147], v[132:135], v[208:211], v[144:147]
    v_mfma_f32_16x16x32_bf16 v[148:151], v[132:135], v[212:215], v[148:151]
    v_mfma_f32_16x16x32_bf16 v[152:155], v[132:135], v[216:219], v[152:155]
    v_mfma_f32_16x16x32_bf16 v[156:159], v[132:135], v[220:223], v[156:159]
    s_waitcnt lgkmcnt(6)
    v_mfma_f32_16x16x32_bf16 v[144:147], v[136:139], v[224:227], v[144:147]
    v_mfma_f32_16x16x32_bf16 v[148:151], v[136:139], v[228:231], v[148:151]
    v_mfma_f32_16x16x32_bf16 v[152:155], v[136:139], v[232:235], v[152:155]
    v_mfma_f32_16x16x32_bf16 v[156:159], v[136:139], v[236:239], v[156:159]
    s_waitcnt lgkmcnt(5)
    v_mfma_f32_16x16x32_bf16 v[144:147], v[140:143], v[240:243], v[144:147]
    v_mfma_f32_16x16x32_bf16 v[148:151], v[140:143], v[244:247], v[148:151]
    v_mfma_f32_16x16x32_bf16 v[152:155], v[140:143], v[248:251], v[152:155]
    v_mfma_f32_16x16x32_bf16 v[156:159], v[140:143], v[252:255], v[156:159]
    s_waitcnt lgkmcnt(0)
    v_max3_f32 v32, v160, v162, v164
    v_max3_f32 v33, v166, v168, v170
    v_max3_f32 v32, v32, v172, v174
    v_max_f32 v12, v32, v33
    v_sub_f32 v34, v176, v12
    v_sub_f32 v35, v178, v12
    v_exp_f32 v34, v34
    v_exp_f32 v35, v35
    v_sub_f32 v160, v160, v12
    v_sub_f32 v162, v162, v12
    v_sub_f32 v164, v164, v12
    v_sub_f32 v166, v166, v12
    v_sub_f32 v168, v168, v12
    v_sub_f32 v170, v170, v12
    v_sub_f32 v172, v172, v12
    v_sub_f32 v174, v174, v12
    v_exp_f32 v160, v160
    v_exp_f32 v162, v162
    v_exp_f32 v164, v164
    v_exp_f32 v166, v166
    v_exp_f32 v168, v168
    v_exp_f32 v170, v170
    v_exp_f32 v172, v172
    v_exp_f32 v174, v174
    v_mul_f32 v13, v160, v161
    v_fmac_f32 v13, v162, v163
    v_fmac_f32 v13, v164, v165
    v_fmac_f32 v13, v166, v167
    v_fmac_f32 v13, v168, v169
    v_fmac_f32 v13, v170, v171
    v_fmac_f32 v13, v172, v173
    v_fmac_f32 v13, v174, v175
    v_add_f32 v144, v144, v145
    v_add_f32 v146, v146, v147
    v_add_f32 v148, v148, v149
    v_add_f32 v150, v150, v151
    v_add_f32 v152, v152, v153
    v_add_f32 v154, v154, v155
    v_add_f32 v156, v156, v157
    v_add_f32 v158, v158, v159
    v_mul_f32 v36, v34, v144
    v_mul_f32 v37, v34, v148
    v_mul_f32 v38, v34, v152
    v_mul_f32 v39, v34, v156
    v_fmac_f32 v36, v35, v146
    v_fmac_f32 v37, v35, v150
    v_fmac_f32 v38, v35, v154
    v_fmac_f32 v39, v35, v158
    v_permlane32_swap_b32 v36, v37
    s_nop 0
    v_permlane32_swap_b32 v38, v39
    v_add_f32 v36, v36, v37
    v_add_f32 v38, v38, v39
    s_nop 1
    v_permlane16_swap_b32 v36, v38
    v_add_f32 v36, v36, v38
    global_store_dword v63, v36, s[34:35]
    s_cmp_lg_u32 s32, 0
    s_cbranch_scc1 L_main_end
    s_mov_b64 exec, 1
    global_store_dwordx2 v58, v[12:13], s[40:41]
L_main_end:
    s_endpgm
.globl final_reduce_kernel
.p2align 8
.type final_reduce_kernel,@function
final_reduce_kernel:
    s_cmp_ge_u32 s2, 32
    s_cbranch_scc1 L_fin_end
    s_load_dwordx2 s[4:5], s[0:1], 0
    s_load_dwordx2 s[22:23], s[0:1], 72
    s_load_dwordx2 s[26:27], s[0:1], 88
    s_lshr_b32 s29, s2, 3
    s_and_b32 s28, s2, 7
    v_and_b32 v2, 15, v0
    v_lshrrev_b32 v3, 4, v0
    v_lshrrev_b32 v4, 6, v0
    s_nop 0
    v_readfirstlane_b32 s46, v4
    s_waitcnt lgkmcnt(0)
    s_lshl_b32 s33, s29, 17
    s_lshl_b32 s34, s28, 8
    s_add_u32 s33, s33, s34
    s_add_u32 s36, s26, s33
    s_addc_u32 s37, s27, 0
    s_add_u32 s38, s36, 1048576
    s_addc_u32 s39, s37, 0
    s_lshl_b32 s33, s29, 9
    s_add_u32 s33, s33, 524288
    s_add_u32 s40, s26, s33
    s_addc_u32 s41, s27, 0
    v_lshlrev_b32 v4, 12, v3
    v_lshl_add_u32 v4, v2, 4, v4
    v_add_u32 v5, 0x10000, v4
    v_lshlrev_b32 v6, 4, v3
    global_load_dwordx4 v[8:11], v6, s[40:41]
    global_load_dwordx4 v[12:15], v6, s[40:41] offset:256
    global_load_dwordx4 v[16:19], v4, s[36:37]
    global_load_dwordx4 v[20:23], v4, s[36:37] offset:2048
    global_load_dwordx4 v[24:27], v5, s[36:37]
    global_load_dwordx4 v[28:31], v5, s[36:37] offset:2048
    v_lshlrev_b32 v7, 11, v3
    v_lshl_add_u32 v7, v2, 4, v7
    global_load_dwordx4 v[32:35], v7, s[38:39]
    v_add_u32 v7, 0x8000, v7
    global_load_dwordx4 v[36:39], v7, s[38:39]
    v_add_u32 v7, 0x8000, v7
    global_load_dwordx4 v[40:43], v7, s[38:39]
    v_add_u32 v7, 0x8000, v7
    v_mov_b32 v44, 0
    v_mov_b32 v45, 0
    v_mov_b32 v46, 0
    v_mov_b32 v47, 0
    v_cmp_gt_u32 vcc, 8, v3
    s_nop 0
    s_and_saveexec_b64 s[52:53], vcc
    s_cbranch_execz L_fin_noz
    global_load_dwordx4 v[44:47], v7, s[38:39]
L_fin_noz:
    s_mov_b64 exec, s[52:53]
    s_lshl_b32 s33, s29, 10
    s_lshl_b32 s34, s28, 7
    s_add_u32 s33, s33, s34
    s_add_u32 s42, s4, s33
    s_addc_u32 s43, s5, 0
    s_add_u32 s44, s22, s33
    s_addc_u32 s45, s23, 0
    v_lshlrev_b32 v1, 3, v2
    global_load_dwordx2 v[60:61], v1, s[42:43]
    s_waitcnt vmcnt(0)
    v_max_f32 v48, v8, v10
    v_sub_f32 v49, v8, v48
    v_sub_f32 v50, v10, v48
    v_exp_f32 v49, v49
    v_exp_f32 v50, v50
    v_mul_f32 v51, v49, v9
    v_fmac_f32 v51, v50, v11
    v_rcp_f32 v52, v51
    s_nop 0
    v_fma_f32 v53, -v52, v51, 1.0
    v_fmac_f32 v52, v53, v52
    v_mul_f32 v49, v49, v52
    v_mul_f32 v50, v50, v52
    v_mul_f32 v54, v49, v16
    v_fmac_f32 v54, v50, v20
    v_mul_f32 v55, v49, v17
    v_fmac_f32 v55, v50, v21
    v_mul_f32 v56, v49, v18
    v_fmac_f32 v56, v50, v22
    v_mul_f32 v57, v49, v19
    v_fmac_f32 v57, v50, v23
    v_max_f32 v48, v12, v14
    v_sub_f32 v49, v12, v48
    v_sub_f32 v50, v14, v48
    v_exp_f32 v49, v49
    v_exp_f32 v50, v50
    v_mul_f32 v51, v49, v13
    v_fmac_f32 v51, v50, v15
    v_rcp_f32 v52, v51
    s_nop 0
    v_fma_f32 v53, -v52, v51, 1.0
    v_fmac_f32 v52, v53, v52
    v_mul_f32 v49, v49, v52
    v_mul_f32 v50, v50, v52
    v_fmac_f32 v54, v49, v24
    v_fmac_f32 v54, v50, v28
    v_fmac_f32 v55, v49, v25
    v_fmac_f32 v55, v50, v29
    v_fmac_f32 v56, v49, v26
    v_fmac_f32 v56, v50, v30
    v_fmac_f32 v57, v49, v27
    v_fmac_f32 v57, v50, v31
    v_add_f32 v32, v32, v36
    v_add_f32 v40, v40, v44
    v_add_f32 v32, v32, v40
    v_add_f32 v33, v33, v37
    v_add_f32 v41, v41, v45
    v_add_f32 v33, v33, v41
    v_add_f32 v34, v34, v38
    v_add_f32 v42, v42, v46
    v_add_f32 v34, v34, v42
    v_add_f32 v35, v35, v39
    v_add_f32 v43, v43, v47
    v_add_f32 v35, v35, v43
    v_lshlrev_b32 v4, 4, v0
    ds_write_b128 v4, v[54:57]
    ds_write_b128 v4, v[32:35] offset:4096
    s_waitcnt lgkmcnt(0)
    s_barrier
    s_cmp_lg_u32 s46, 0
    s_cbranch_scc1 L_fin_end
    v_and_b32 v4, 1, v3
    v_lshlrev_b32 v4, 12, v4
    v_lshl_add_u32 v4, v2, 4, v4
    ds_read_b128 v[64:67], v4 offset:0
    ds_read_b128 v[68:71], v4 offset:256
    ds_read_b128 v[72:75], v4 offset:512
    ds_read_b128 v[76:79], v4 offset:768
    ds_read_b128 v[80:83], v4 offset:1024
    ds_read_b128 v[84:87], v4 offset:1280
    ds_read_b128 v[88:91], v4 offset:1536
    ds_read_b128 v[92:95], v4 offset:1792
    ds_read_b128 v[96:99], v4 offset:2048
    ds_read_b128 v[100:103], v4 offset:2304
    ds_read_b128 v[104:107], v4 offset:2560
    ds_read_b128 v[108:111], v4 offset:2816
    ds_read_b128 v[112:115], v4 offset:3072
    ds_read_b128 v[116:119], v4 offset:3328
    ds_read_b128 v[120:123], v4 offset:3584
    ds_read_b128 v[124:127], v4 offset:3840
    s_waitcnt lgkmcnt(0)
    v_add_f32 v64, v64, v96
    v_add_f32 v65, v65, v97
    v_add_f32 v66, v66, v98
    v_add_f32 v67, v67, v99
    v_add_f32 v68, v68, v100
    v_add_f32 v69, v69, v101
    v_add_f32 v70, v70, v102
    v_add_f32 v71, v71, v103
    v_add_f32 v72, v72, v104
    v_add_f32 v73, v73, v105
    v_add_f32 v74, v74, v106
    v_add_f32 v75, v75, v107
    v_add_f32 v76, v76, v108
    v_add_f32 v77, v77, v109
    v_add_f32 v78, v78, v110
    v_add_f32 v79, v79, v111
    v_add_f32 v80, v80, v112
    v_add_f32 v81, v81, v113
    v_add_f32 v82, v82, v114
    v_add_f32 v83, v83, v115
    v_add_f32 v84, v84, v116
    v_add_f32 v85, v85, v117
    v_add_f32 v86, v86, v118
    v_add_f32 v87, v87, v119
    v_add_f32 v88, v88, v120
    v_add_f32 v89, v89, v121
    v_add_f32 v90, v90, v122
    v_add_f32 v91, v91, v123
    v_add_f32 v92, v92, v124
    v_add_f32 v93, v93, v125
    v_add_f32 v94, v94, v126
    v_add_f32 v95, v95, v127
    v_add_f32 v64, v64, v80
    v_add_f32 v65, v65, v81
    v_add_f32 v66, v66, v82
    v_add_f32 v67, v67, v83
    v_add_f32 v68, v68, v84
    v_add_f32 v69, v69, v85
    v_add_f32 v70, v70, v86
    v_add_f32 v71, v71, v87
    v_add_f32 v72, v72, v88
    v_add_f32 v73, v73, v89
    v_add_f32 v74, v74, v90
    v_add_f32 v75, v75, v91
    v_add_f32 v76, v76, v92
    v_add_f32 v77, v77, v93
    v_add_f32 v78, v78, v94
    v_add_f32 v79, v79, v95
    v_add_f32 v64, v64, v72
    v_add_f32 v65, v65, v73
    v_add_f32 v66, v66, v74
    v_add_f32 v67, v67, v75
    v_add_f32 v68, v68, v76
    v_add_f32 v69, v69, v77
    v_add_f32 v70, v70, v78
    v_add_f32 v71, v71, v79
    v_add_f32 v64, v64, v68
    v_add_f32 v65, v65, v69
    v_add_f32 v66, v66, v70
    v_add_f32 v67, v67, v71
    v_mov_b32 v8, v64
    v_mov_b32 v12, v64
    v_mov_b32 v9, v65
    v_mov_b32 v13, v65
    v_mov_b32 v10, v66
    v_mov_b32 v14, v66
    v_mov_b32 v11, v67
    v_mov_b32 v15, v67
    v_permlane16_swap_b32 v8, v12
    v_permlane16_swap_b32 v9, v13
    v_permlane16_swap_b32 v10, v14
    v_permlane16_swap_b32 v11, v15
    v_cmp_gt_u32 vcc, 16, v0
    s_nop 0
    s_and_saveexec_b64 s[52:53], vcc
    v_cvt_pk_bf16_f32 v16, v8, v9
    v_cvt_pk_bf16_f32 v17, v10, v11
    v_cvt_pk_bf16_f32 v18, v12, v13
    v_cvt_pk_bf16_f32 v19, v14, v15
    v_lshlrev_b32 v20, 16, v16
    v_and_b32 v21, 0xffff0000, v16
    v_lshlrev_b32 v22, 16, v60
    v_and_b32 v23, 0xffff0000, v60
    v_add_f32 v20, v22, v20
    v_add_f32 v21, v23, v21
    v_cvt_pk_bf16_f32 v24, v20, v21
    v_lshlrev_b32 v20, 16, v24
    v_and_b32 v21, 0xffff0000, v24
    v_lshlrev_b32 v22, 16, v18
    v_and_b32 v23, 0xffff0000, v18
    v_add_f32 v20, v20, v22
    v_add_f32 v21, v21, v23
    v_cvt_pk_bf16_f32 v26, v20, v21
    v_lshlrev_b32 v20, 16, v17
    v_and_b32 v21, 0xffff0000, v17
    v_lshlrev_b32 v22, 16, v61
    v_and_b32 v23, 0xffff0000, v61
    v_add_f32 v20, v22, v20
    v_add_f32 v21, v23, v21
    v_cvt_pk_bf16_f32 v24, v20, v21
    v_lshlrev_b32 v20, 16, v24
    v_and_b32 v21, 0xffff0000, v24
    v_lshlrev_b32 v22, 16, v19
    v_and_b32 v23, 0xffff0000, v19
    v_add_f32 v20, v20, v22
    v_add_f32 v21, v21, v23
    v_cvt_pk_bf16_f32 v27, v20, v21
    global_store_dwordx2 v1, v[26:27], s[44:45]
L_fin_end:
    s_endpgm
.section .rodata,"a"
.p2align 6
.amdhsa_kernel parallel_sum__mha_block_cached__swiglu_ffn__decode_kernel
  .amdhsa_next_free_vgpr 256
  .amdhsa_next_free_sgpr 96
  .amdhsa_accum_offset 256
  .amdhsa_group_segment_fixed_size 0
  .amdhsa_kernarg_size 96
  .amdhsa_user_sgpr_count 2
  .amdhsa_user_sgpr_kernarg_segment_ptr 1
  .amdhsa_system_sgpr_workgroup_id_x 1
  .amdhsa_float_denorm_mode_32 3
  .amdhsa_float_denorm_mode_16_64 3
.end_amdhsa_kernel
.p2align 6
.amdhsa_kernel final_reduce_kernel
  .amdhsa_next_free_vgpr 128
  .amdhsa_next_free_sgpr 64
  .amdhsa_accum_offset 128
  .amdhsa_group_segment_fixed_size 0
  .amdhsa_kernarg_size 96
  .amdhsa_user_sgpr_count 2
  .amdhsa_user_sgpr_kernarg_segment_ptr 1
  .amdhsa_system_sgpr_workgroup_id_x 1
  .amdhsa_float_denorm_mode_32 3
  .amdhsa_float_denorm_mode_16_64 3
.end_amdhsa_kernel
```
